```python
import torch

def _softmax(x, axis=-1):
    return torch.softmax(x, dim=axis)
def _gelu(x):
    return torch.nn.functional.gelu(x, approximate="tanh")
def _silu(x):
    return torch.nn.functional.silu(x)
def _sigmoid(x):
    return torch.sigmoid(x)
def _layernorm(x, axis=-1, eps=1e-5):
    m = x.mean(dim=axis, keepdim=True)
    v = x.var(dim=axis, keepdim=True, unbiased=False)
    return (x - m) / torch.sqrt(v + eps)
def _scatter_add(tgt, idx, src, axis=0):
    return tgt.clone().index_add_(axis, idx, src)
def _segment_sum(src, seg, n):
    out = torch.zeros((n,) + src.shape[1:], dtype=src.dtype)
    return out.index_add_(0, seg, src)
def _pad(x, pw):
    flat = tuple(v for pair in reversed(pw) for v in pair)
    return torch.nn.functional.pad(x, flat)

kernel_name = 'recurrent_scan__mha_block_cached__dense_activation_silu__decode'

def setup_inputs():

    _w = (lambda a: (lambda t: t.to(torch.bfloat16) if t.is_floating_point() else t)(torch.as_tensor(a)))
    def _A_setup():
        B, Sq, D = 1, 1, 448
        H, Sk, Dh = 16, 65536, 256
        return {
            "x": _w((lambda *s: torch.randn(*s, dtype=torch.bfloat16) * 0.4)(B, Sq, D)),
            "k_cache": _w((lambda *s: torch.randn(*s, dtype=torch.bfloat16) * 1.6)(B, H, Sk, Dh)),
            "v_cache": _w((lambda *s: torch.randn(*s, dtype=torch.bfloat16) * 1.6)(B, H, Sk, Dh)),
            "wq": _w((lambda *s: torch.randn(*s, dtype=torch.bfloat16) * 1.6)(D, H * Dh) * (D ** -0.5)),
            "wo": _w((lambda *s: torch.randn(*s, dtype=torch.bfloat16) * 1.6)(H * Dh, D) * ((H * Dh) ** -0.5)),
        }
    _A_in = _A_setup()

    def _B_setup():
        B, S, D, F = 1, 1, 448, 1792
        return {
            "x": _w((lambda *s: torch.randn(*s, dtype=torch.bfloat16) * 0.4)(B, S, D)),
            "w1": _w((lambda *s: torch.randn(*s, dtype=torch.bfloat16) * 1.6)(D, F) * (D ** -0.5)),
            "w2": _w((lambda *s: torch.randn(*s, dtype=torch.bfloat16) * 1.6)(F, D) * (F ** -0.5)),
        }
    _B_in = _B_setup()

    return {
        "A_x": _A_in["x"],
        "A_k_cache": _A_in["k_cache"],
        "A_v_cache": _A_in["v_cache"],
        "A_wq": _A_in["wq"],
        "A_wo": _A_in["wo"],
        "B_x": _B_in["x"],
        "B_w1": _B_in["w1"],
        "B_w2": _B_in["w2"],
    }

def reference(A_x, A_k_cache, A_v_cache, A_wq, A_wo, B_x, B_w1, B_w2):
    def _A_ref(x, k_cache, v_cache, wq, wo):
        B, Sq, D = x.shape
        H, Dh = 16, 256
        q = (lambda x, *d: x.permute(*d))((x @ wq).reshape(B, Sq, H, Dh), 0, 2, 1, 3)
        scores = torch.einsum("bhqd,bhkd->bhqk", q, k_cache) * (Dh ** -0.5)
        p = _softmax(scores, axis=-1)
        o = torch.einsum("bhqk,bhkd->bhqd", p, v_cache)
        return (lambda x, *d: x.permute(*d))(o, 0, 2, 1, 3).reshape(B, Sq, H * Dh) @ wo

    def _B_ref(x, w1, w2):
        h = torch.einsum("bsd,df->bsf", x, w1)
        h = _silu(h)
        out = torch.einsum("bsf,fd->bsd", h, w2)
        return out

    x = A_x
    xn = _layernorm(x, axis=-1)
    s = _A_ref(xn, A_k_cache, A_v_cache, A_wq, A_wo)
    g = _silu(_B_ref(xn, B_w1, B_w2))
    return x + s * g
```

```asm
; @launch grid=(256,1,1) block=(320,1,1) lds=17408
.amdgcn_target "amdgcn-amd-amdhsa--gfx950"
.text
.globl recurrent_scan__mha_block_cached__dense_activation_silu__decode_kernel
.p2align 8
.type recurrent_scan__mha_block_cached__dense_activation_silu__decode_kernel,@function
recurrent_scan__mha_block_cached__dense_activation_silu__decode_kernel:
    s_cmp_ge_u32 s2, 256
    s_cbranch_scc1 L_end
    s_load_dwordx16 s[4:19], s[0:1], 0
    s_load_dwordx4 s[20:23], s[0:1], 64
    s_load_dwordx2 s[24:25], s[0:1], 80
    s_getpc_b64 s[94:95]
L_pc:
    v_lshlrev_b32 v2, 6, v0
    v_min_u32 v2, L_end-L_pc, v2
    global_load_dword v231, v2, s[94:95]
    v_lshrrev_b32 v1, 6, v0
    v_and_b32 v0, 63, v0
    v_readfirstlane_b32 s3, v1
    s_lshr_b32 s26, s2, 4
    s_and_b32 s27, s2, 15
    v_lshrrev_b32 v3, 4, v0
    v_and_b32 v4, 15, v0
    s_cmp_eq_u32 s3, 4
    s_cbranch_scc1 L_helper
    v_lshlrev_b32 v1, 9, v3
    v_lshl_add_u32 v1, v4, 4, v1
    s_lshl_b32 s40, s26, 25
    s_mul_i32 s41, s27, 512
    s_add_u32 s41, s41, s3
    s_lshl_b32 s46, s41, 12
    s_add_u32 s48, s46, s40
    s_add_u32 s49, s48, 16384
    s_add_u32 s50, s48, 32768
    s_add_u32 s39, s48, 49152
    s_mov_b32 s36, s48
    s_waitcnt lgkmcnt(0)
    s_mov_b32 s28, s6
    s_mov_b32 s29, s7
    s_mov_b32 s30, 536870912
    s_mov_b32 s31, 0x20000
    s_mov_b32 s32, s8
    s_mov_b32 s33, s9
    s_mov_b32 s34, 536870912
    s_mov_b32 s35, 0x20000
    buffer_load_dwordx4 v[36:39], v1, s[28:31], s48 offen offset:0 nt
    buffer_load_dwordx4 v[40:43], v1, s[28:31], s48 offen offset:256 nt
    buffer_load_dwordx4 v[44:47], v1, s[28:31], s48 offen offset:2048 nt
    buffer_load_dwordx4 v[48:51], v1, s[28:31], s48 offen offset:2304 nt
    buffer_load_dwordx4 v[52:55], v1, s[28:31], s49 offen offset:0 nt
    buffer_load_dwordx4 v[56:59], v1, s[28:31], s49 offen offset:256 nt
    buffer_load_dwordx4 v[60:63], v1, s[28:31], s49 offen offset:2048 nt
    buffer_load_dwordx4 v[64:67], v1, s[28:31], s49 offen offset:2304 nt
    s_mov_b32 s56, s24
    s_mov_b32 s57, s25
    s_mov_b32 s58, 4194304
    s_mov_b32 s59, 0x20000
    v_lshrrev_b32 v6, 1, v3
    v_lshlrev_b32 v6, 3, v6
    v_lshrrev_b32 v7, 1, v4
    v_add_u32 v6, v6, v7
    v_lshlrev_b32 v2, 12, v6
    v_and_b32 v6, 1, v4
    v_lshlrev_b32 v6, 5, v6
    v_and_b32 v7, 1, v3
    v_lshlrev_b32 v7, 4, v7
    v_or3_b32 v2, v2, v6, v7
    s_lshl_b32 s54, s27, 2
    s_add_u32 s54, s54, s3
    s_lshl_b32 s52, s26, 16
    s_lshl_b32 s55, s54, 6
    s_add_u32 s52, s52, s55
    s_add_u32 s52, s52, 1048576
    s_lshl_b32 s53, s26, 10
    s_lshl_b32 s55, s54, 4
    s_add_u32 s53, s53, s55
    s_add_u32 s53, s53, 65536
    v_mov_b32 v20, 0
    v_mov_b32 v21, 0
    v_mov_b32 v22, 0
    v_mov_b32 v23, 0
    v_mov_b32 v24, 0
    v_mov_b32 v25, 0
    v_mov_b32 v26, 0
    v_mov_b32 v27, 0
    v_mov_b32 v28, 0
    v_mov_b32 v29, 0
    v_mov_b32 v30, 0
    v_mov_b32 v31, 0
    v_mov_b32 v32, 0
    v_mov_b32 v33, 0
    v_mov_b32 v34, 0
    v_mov_b32 v35, 0
    s_add_u32 s41, s41, 4
    s_mov_b32 s42, 119
    s_mov_b32 s51, 4
    s_mov_b32 s37, 0
    s_add_u32 s45, s3, 480
    s_lshl_b32 s44, s26, 2
    s_add_u32 s44, s44, s3
    s_lshl_b32 s44, s44, 12
    s_add_u32 s44, s44, 3145728
    s_mov_b32 s47, 1035512379
    s_mov_b32 s60, 0
    s_mov_b32 s63, 4194304
    v_lshlrev_b32 v8, 4, v4
    v_mov_b32 v10, 512
    v_mov_b32 v3, 0xff7fffff
    v_mov_b32 v5, 0
    v_mul_f32 v4, s47, v3
    v_sub_f32 v4, 0, v4
    s_barrier
    ds_read_b64 v[6:7], v10
    ds_read_b128 v[12:15], v8
    ds_read_b128 v[16:19], v8 offset:256
    s_waitcnt lgkmcnt(0)
    v_readfirstlane_b32 s62, v6
    s_nop 0
    s_cmp_lg_u32 s62, 0
    s_cbranch_scc1 L_go
    s_waitcnt vmcnt(7)
    buffer_load_dwordx4 v[100:103], v1, s[28:31], s50 offen offset:0 nt
    s_waitcnt vmcnt(7)
    buffer_load_dwordx4 v[104:107], v1, s[28:31], s50 offen offset:256 nt
    s_waitcnt vmcnt(7)
    buffer_load_dwordx4 v[108:111], v1, s[28:31], s50 offen offset:2048 nt
    s_waitcnt vmcnt(7)
    buffer_load_dwordx4 v[112:115], v1, s[28:31], s50 offen offset:2304 nt
    s_waitcnt vmcnt(7)
    buffer_load_dwordx4 v[116:119], v1, s[28:31], s39 offen offset:0 nt
    s_waitcnt vmcnt(7)
    buffer_load_dwordx4 v[120:123], v1, s[28:31], s39 offen offset:256 nt
    s_waitcnt vmcnt(7)
    buffer_load_dwordx4 v[124:127], v1, s[28:31], s39 offen offset:2048 nt
    s_waitcnt vmcnt(7)
    buffer_load_dwordx4 v[128:131], v1, s[28:31], s39 offen offset:2304 nt
    s_add_u32 s50, s50, 32768
    s_add_u32 s60, s60, 1
    s_add_u32 s39, s39, 32768
    ds_read_b64 v[6:7], v10
    ds_read_b128 v[12:15], v8
    ds_read_b128 v[16:19], v8 offset:256
    s_waitcnt lgkmcnt(0)
    v_readfirstlane_b32 s62, v6
    s_nop 0
    s_cmp_lg_u32 s62, 0
    s_cbranch_scc1 L_go
    s_waitcnt vmcnt(7)
    buffer_load_dwordx4 v[132:135], v1, s[28:31], s50 offen offset:0 nt
    s_waitcnt vmcnt(7)
    buffer_load_dwordx4 v[136:139], v1, s[28:31], s50 offen offset:256 nt
    s_waitcnt vmcnt(7)
    buffer_load_dwordx4 v[140:143], v1, s[28:31], s50 offen offset:2048 nt
    s_waitcnt vmcnt(7)
    buffer_load_dwordx4 v[144:147], v1, s[28:31], s50 offen offset:2304 nt
    s_waitcnt vmcnt(7)
    buffer_load_dwordx4 v[148:151], v1, s[28:31], s39 offen offset:0 nt
    s_waitcnt vmcnt(7)
    buffer_load_dwordx4 v[152:155], v1, s[28:31], s39 offen offset:256 nt
    s_waitcnt vmcnt(7)
    buffer_load_dwordx4 v[156:159], v1, s[28:31], s39 offen offset:2048 nt
    s_waitcnt vmcnt(7)
    buffer_load_dwordx4 v[160:163], v1, s[28:31], s39 offen offset:2304 nt
    s_add_u32 s50, s50, 32768
    s_add_u32 s60, s60, 1
    s_add_u32 s39, s39, 32768
    ds_read_b64 v[6:7], v10
    ds_read_b128 v[12:15], v8
    ds_read_b128 v[16:19], v8 offset:256
    s_waitcnt lgkmcnt(0)
    v_readfirstlane_b32 s62, v6
    s_nop 0
    s_cmp_lg_u32 s62, 0
    s_cbranch_scc1 L_go
    s_waitcnt vmcnt(7)
    buffer_load_dwordx4 v[164:167], v1, s[28:31], s50 offen offset:0 nt
    s_waitcnt vmcnt(7)
    buffer_load_dwordx4 v[168:171], v1, s[28:31], s50 offen offset:256 nt
    s_waitcnt vmcnt(7)
    buffer_load_dwordx4 v[172:175], v1, s[28:31], s50 offen offset:2048 nt
    s_waitcnt vmcnt(7)
    buffer_load_dwordx4 v[176:179], v1, s[28:31], s50 offen offset:2304 nt
    s_waitcnt vmcnt(7)
    buffer_load_dwordx4 v[180:183], v1, s[28:31], s39 offen offset:0 nt
    s_waitcnt vmcnt(7)
    buffer_load_dwordx4 v[184:187], v1, s[28:31], s39 offen offset:256 nt
    s_waitcnt vmcnt(7)
    buffer_load_dwordx4 v[188:191], v1, s[28:31], s39 offen offset:2048 nt
    s_waitcnt vmcnt(7)
    buffer_load_dwordx4 v[192:195], v1, s[28:31], s39 offen offset:2304 nt
    s_add_u32 s50, s50, 32768
    s_add_u32 s60, s60, 1
    s_add_u32 s39, s39, 32768
    ds_read_b64 v[6:7], v10
    ds_read_b128 v[12:15], v8
    ds_read_b128 v[16:19], v8 offset:256
    s_waitcnt lgkmcnt(0)
    v_readfirstlane_b32 s62, v6
    s_nop 0
    s_cmp_lg_u32 s62, 0
    s_cbranch_scc1 L_go
    s_waitcnt vmcnt(7)
    buffer_load_dwordx4 v[196:199], v1, s[28:31], s50 offen offset:0 nt
    s_waitcnt vmcnt(7)
    buffer_load_dwordx4 v[200:203], v1, s[28:31], s50 offen offset:256 nt
    s_waitcnt vmcnt(7)
    buffer_load_dwordx4 v[204:207], v1, s[28:31], s50 offen offset:2048 nt
    s_waitcnt vmcnt(7)
    buffer_load_dwordx4 v[208:211], v1, s[28:31], s50 offen offset:2304 nt
    s_waitcnt vmcnt(7)
    buffer_load_dwordx4 v[212:215], v1, s[28:31], s39 offen offset:0 nt
    s_waitcnt vmcnt(7)
    buffer_load_dwordx4 v[216:219], v1, s[28:31], s39 offen offset:256 nt
    s_waitcnt vmcnt(7)
    buffer_load_dwordx4 v[220:223], v1, s[28:31], s39 offen offset:2048 nt
    s_waitcnt vmcnt(7)
    buffer_load_dwordx4 v[224:227], v1, s[28:31], s39 offen offset:2304 nt
    s_add_u32 s50, s50, 32768
    s_add_u32 s60, s60, 1
    s_add_u32 s39, s39, 32768
L_qspin:
    ds_read_b64 v[6:7], v10
    ds_read_b128 v[12:15], v8
    ds_read_b128 v[16:19], v8 offset:256
    s_waitcnt lgkmcnt(0)
    v_readfirstlane_b32 s62, v6
    s_nop 0
    s_cmp_lg_u32 s62, 0
    s_cbranch_scc1 L_go
    s_sleep 1
    s_sub_u32 s63, s63, 1
    s_cbranch_scc0 L_qspin
    s_branch L_end
L_go:
    v_readfirstlane_b32 s54, v7
    s_lshl_b32 s62, s60, 2
    s_add_u32 s41, s41, s62
    s_sub_u32 s42, s42, s60
    s_sub_u32 s42, 53, s60
    s_mov_b32 s98, 0
    s_lshl_b32 s38, s60, 5
    s_add_u32 s38, s38, 32
    s_mov_b64 s[88:89], s[28:29]
    s_mov_b64 s[90:91], s[30:31]
    s_mov_b64 s[92:93], s[28:29]
    s_mov_b64 s[94:95], s[30:31]
    s_lshl_b32 s62, s3, 12
    s_add_u32 s100, s62, s40
    s_add_u32 s100, s100, 1769472
    s_mov_b32 s101, 0
    s_add_u32 s87, s44, 256
    s_add_u32 s62, s62, 1024
    v_lshrrev_b32 v230, 4, v0
    v_lshl_add_u32 v230, v230, 2, s62
.p2align 6
L_k0:
    s_sub_u32 s42, s42, 1
    s_cbranch_scc1 L_kl0
    s_cmp_lg_u32 s42, 0
    s_cbranch_scc1 L_kn0
    s_mov_b32 s39, 1
    s_atomic_add s39, s[24:25], s87 glc
L_kn0:
    s_mov_b32 s49, s50
    s_add_u32 s97, s50, 16384
    s_add_u32 s50, s50, 32768
    s_mov_b32 s99, s38
    s_add_u32 s38, s38, 32
L_kb0:
    v_add_u32 v228, s98, v230
    s_waitcnt vmcnt(7)
    buffer_load_dwordx4 v[68:71], v1, s[88:91], s49 offen offset:0 nt
    v_dot2_f32_bf16 v6, v36, v12, 0
    v_dot2_f32_bf16 v6, v37, v13, v6
    v_dot2_f32_bf16 v6, v38, v14, v6
    v_dot2_f32_bf16 v6, v39, v15, v6
    s_waitcnt vmcnt(7)
    buffer_load_dwordx4 v[72:75], v1, s[88:91], s49 offen offset:256 nt
    v_dot2_f32_bf16 v6, v40, v16, v6
    v_dot2_f32_bf16 v6, v41, v17, v6
    v_dot2_f32_bf16 v6, v42, v18, v6
    v_dot2_f32_bf16 v6, v43, v19, v6
    s_waitcnt vmcnt(7)
    buffer_load_dwordx4 v[76:79], v1, s[88:91], s49 offen offset:2048 nt
    v_dot2_f32_bf16 v7, v44, v12, 0
    v_dot2_f32_bf16 v7, v45, v13, v7
    v_dot2_f32_bf16 v7, v46, v14, v7
    v_dot2_f32_bf16 v7, v47, v15, v7
    s_waitcnt vmcnt(7)
    buffer_load_dwordx4 v[80:83], v1, s[88:91], s49 offen offset:2304 nt
    v_dot2_f32_bf16 v7, v48, v16, v7
    v_dot2_f32_bf16 v7, v49, v17, v7
    v_dot2_f32_bf16 v7, v50, v18, v7
    v_dot2_f32_bf16 v7, v51, v19, v7
    v_add_f32_dpp v6, v6, v6 quad_perm:[1,0,3,2] row_mask:0xf bank_mask:0xf
    s_nop 1
    v_add_f32_dpp v7, v7, v7 quad_perm:[1,0,3,2] row_mask:0xf bank_mask:0xf
    v_add_f32_dpp v6, v6, v6 quad_perm:[2,3,0,1] row_mask:0xf bank_mask:0xf
    s_nop 0
    v_add_f32_dpp v7, v7, v7 quad_perm:[2,3,0,1] row_mask:0xf bank_mask:0xf
    v_add_f32_dpp v6, v6, v6 row_half_mirror row_mask:0xf bank_mask:0xf
    s_nop 0
    v_add_f32_dpp v7, v7, v7 row_half_mirror row_mask:0xf bank_mask:0xf
    v_add_f32_dpp v6, v6, v6 row_mirror row_mask:0xf bank_mask:0xf
    s_nop 0
    v_add_f32_dpp v7, v7, v7 row_mirror row_mask:0xf bank_mask:0xf
    v_cvt_pk_bf16_f32 v8, v6, v7
    ds_write_b32 v228, v8 offset:0
    v_lshlrev_b32 v6, 16, v8
    v_and_b32 v7, 0xffff0000, v8
    v_max3_f32 v3, v6, v7, v3
    s_waitcnt vmcnt(7)
    buffer_load_dwordx4 v[84:87], v1, s[92:95], s97 offen offset:0 nt
    v_dot2_f32_bf16 v6, v52, v12, 0
    v_dot2_f32_bf16 v6, v53, v13, v6
    v_dot2_f32_bf16 v6, v54, v14, v6
    v_dot2_f32_bf16 v6, v55, v15, v6
    s_waitcnt vmcnt(7)
    buffer_load_dwordx4 v[88:91], v1, s[92:95], s97 offen offset:256 nt
    v_dot2_f32_bf16 v6, v56, v16, v6
    v_dot2_f32_bf16 v6, v57, v17, v6
    v_dot2_f32_bf16 v6, v58, v18, v6
    v_dot2_f32_bf16 v6, v59, v19, v6
    s_waitcnt vmcnt(7)
    buffer_load_dwordx4 v[92:95], v1, s[92:95], s97 offen offset:2048 nt
    v_dot2_f32_bf16 v7, v60, v12, 0
    v_dot2_f32_bf16 v7, v61, v13, v7
    v_dot2_f32_bf16 v7, v62, v14, v7
    v_dot2_f32_bf16 v7, v63, v15, v7
    s_waitcnt vmcnt(7)
    buffer_load_dwordx4 v[96:99], v1, s[92:95], s97 offen offset:2304 nt
    v_dot2_f32_bf16 v7, v64, v16, v7
    v_dot2_f32_bf16 v7, v65, v17, v7
    v_dot2_f32_bf16 v7, v66, v18, v7
    v_dot2_f32_bf16 v7, v67, v19, v7
    v_add_f32_dpp v6, v6, v6 quad_perm:[1,0,3,2] row_mask:0xf bank_mask:0xf
    s_nop 1
    v_add_f32_dpp v7, v7, v7 quad_perm:[1,0,3,2] row_mask:0xf bank_mask:0xf
    v_add_f32_dpp v6, v6, v6 quad_perm:[2,3,0,1] row_mask:0xf bank_mask:0xf
    s_nop 0
    v_add_f32_dpp v7, v7, v7 quad_perm:[2,3,0,1] row_mask:0xf bank_mask:0xf
    v_add_f32_dpp v6, v6, v6 row_half_mirror row_mask:0xf bank_mask:0xf
    s_nop 0
    v_add_f32_dpp v7, v7, v7 row_half_mirror row_mask:0xf bank_mask:0xf
    v_add_f32_dpp v6, v6, v6 row_mirror row_mask:0xf bank_mask:0xf
    s_nop 0
    v_add_f32_dpp v7, v7, v7 row_mirror row_mask:0xf bank_mask:0xf
    v_cvt_pk_bf16_f32 v8, v6, v7
    ds_write_b32 v228, v8 offset:16
    v_lshlrev_b32 v6, 16, v8
    v_and_b32 v7, 0xffff0000, v8
    v_max3_f32 v3, v6, v7, v3
    s_cmp_lg_u32 s37, 0
    s_cbranch_scc1 L_k2v1
L_k1:
    s_sub_u32 s42, s42, 1
    s_cbranch_scc1 L_kl1
    s_cmp_lg_u32 s42, 0
    s_cbranch_scc1 L_kn1
    s_mov_b32 s39, 1
    s_atomic_add s39, s[24:25], s87 glc
L_kn1:
    s_mov_b32 s48, s50
    s_add_u32 s96, s50, 16384
    s_add_u32 s50, s50, 32768
    s_mov_b32 s98, s38
    s_add_u32 s38, s38, 32
L_kb1:
    v_add_u32 v228, s99, v230
    s_waitcnt vmcnt(7)
    buffer_load_dwordx4 v[36:39], v1, s[88:91], s48 offen offset:0 nt
    v_dot2_f32_bf16 v6, v68, v12, 0
    v_dot2_f32_bf16 v6, v69, v13, v6
    v_dot2_f32_bf16 v6, v70, v14, v6
    v_dot2_f32_bf16 v6, v71, v15, v6
    s_waitcnt vmcnt(7)
    buffer_load_dwordx4 v[40:43], v1, s[88:91], s48 offen offset:256 nt
    v_dot2_f32_bf16 v6, v72, v16, v6
    v_dot2_f32_bf16 v6, v73, v17, v6
    v_dot2_f32_bf16 v6, v74, v18, v6
    v_dot2_f32_bf16 v6, v75, v19, v6
    s_waitcnt vmcnt(7)
    buffer_load_dwordx4 v[44:47], v1, s[88:91], s48 offen offset:2048 nt
    v_dot2_f32_bf16 v7, v76, v12, 0
    v_dot2_f32_bf16 v7, v77, v13, v7
    v_dot2_f32_bf16 v7, v78, v14, v7
    v_dot2_f32_bf16 v7, v79, v15, v7
    s_waitcnt vmcnt(7)
    buffer_load_dwordx4 v[48:51], v1, s[88:91], s48 offen offset:2304 nt
    v_dot2_f32_bf16 v7, v80, v16, v7
    v_dot2_f32_bf16 v7, v81, v17, v7
    v_dot2_f32_bf16 v7, v82, v18, v7
    v_dot2_f32_bf16 v7, v83, v19, v7
    v_add_f32_dpp v6, v6, v6 quad_perm:[1,0,3,2] row_mask:0xf bank_mask:0xf
    s_nop 1
    v_add_f32_dpp v7, v7, v7 quad_perm:[1,0,3,2] row_mask:0xf bank_mask:0xf
    v_add_f32_dpp v6, v6, v6 quad_perm:[2,3,0,1] row_mask:0xf bank_mask:0xf
    s_nop 0
    v_add_f32_dpp v7, v7, v7 quad_perm:[2,3,0,1] row_mask:0xf bank_mask:0xf
    v_add_f32_dpp v6, v6, v6 row_half_mirror row_mask:0xf bank_mask:0xf
    s_nop 0
    v_add_f32_dpp v7, v7, v7 row_half_mirror row_mask:0xf bank_mask:0xf
    v_add_f32_dpp v6, v6, v6 row_mirror row_mask:0xf bank_mask:0xf
    s_nop 0
    v_add_f32_dpp v7, v7, v7 row_mirror row_mask:0xf bank_mask:0xf
    v_cvt_pk_bf16_f32 v8, v6, v7
    ds_write_b32 v228, v8 offset:0
    v_lshlrev_b32 v6, 16, v8
    v_and_b32 v7, 0xffff0000, v8
    v_max3_f32 v3, v6, v7, v3
    s_waitcnt vmcnt(7)
    buffer_load_dwordx4 v[52:55], v1, s[92:95], s96 offen offset:0 nt
    v_dot2_f32_bf16 v6, v84, v12, 0
    v_dot2_f32_bf16 v6, v85, v13, v6
    v_dot2_f32_bf16 v6, v86, v14, v6
    v_dot2_f32_bf16 v6, v87, v15, v6
    s_waitcnt vmcnt(7)
    buffer_load_dwordx4 v[56:59], v1, s[92:95], s96 offen offset:256 nt
    v_dot2_f32_bf16 v6, v88, v16, v6
    v_dot2_f32_bf16 v6, v89, v17, v6
    v_dot2_f32_bf16 v6, v90, v18, v6
    v_dot2_f32_bf16 v6, v91, v19, v6
    s_waitcnt vmcnt(7)
    buffer_load_dwordx4 v[60:63], v1, s[92:95], s96 offen offset:2048 nt
    v_dot2_f32_bf16 v7, v92, v12, 0
    v_dot2_f32_bf16 v7, v93, v13, v7
    v_dot2_f32_bf16 v7, v94, v14, v7
    v_dot2_f32_bf16 v7, v95, v15, v7
    s_waitcnt vmcnt(7)
    buffer_load_dwordx4 v[64:67], v1, s[92:95], s96 offen offset:2304 nt
    v_dot2_f32_bf16 v7, v96, v16, v7
    v_dot2_f32_bf16 v7, v97, v17, v7
    v_dot2_f32_bf16 v7, v98, v18, v7
    v_dot2_f32_bf16 v7, v99, v19, v7
    v_add_f32_dpp v6, v6, v6 quad_perm:[1,0,3,2] row_mask:0xf bank_mask:0xf
    s_nop 1
    v_add_f32_dpp v7, v7, v7 quad_perm:[1,0,3,2] row_mask:0xf bank_mask:0xf
    v_add_f32_dpp v6, v6, v6 quad_perm:[2,3,0,1] row_mask:0xf bank_mask:0xf
    s_nop 0
    v_add_f32_dpp v7, v7, v7 quad_perm:[2,3,0,1] row_mask:0xf bank_mask:0xf
    v_add_f32_dpp v6, v6, v6 row_half_mirror row_mask:0xf bank_mask:0xf
    s_nop 0
    v_add_f32_dpp v7, v7, v7 row_half_mirror row_mask:0xf bank_mask:0xf
    v_add_f32_dpp v6, v6, v6 row_mirror row_mask:0xf bank_mask:0xf
    s_nop 0
    v_add_f32_dpp v7, v7, v7 row_mirror row_mask:0xf bank_mask:0xf
    v_cvt_pk_bf16_f32 v8, v6, v7
    ds_write_b32 v228, v8 offset:16
    v_lshlrev_b32 v6, 16, v8
    v_and_b32 v7, 0xffff0000, v8
    v_max3_f32 v3, v6, v7, v3
    s_cmp_lg_u32 s37, 0
    s_cbranch_scc1 L_k2v0
    s_cmp_eq_u32 s60, 0
    s_cbranch_scc1 L_k0
    v_dot2_f32_bf16 v6, v100, v12, 0
    v_dot2_f32_bf16 v6, v101, v13, v6
    v_dot2_f32_bf16 v6, v102, v14, v6
    v_dot2_f32_bf16 v6, v103, v15, v6
    v_dot2_f32_bf16 v6, v104, v16, v6
    v_dot2_f32_bf16 v6, v105, v17, v6
    v_dot2_f32_bf16 v6, v106, v18, v6
    v_dot2_f32_bf16 v6, v107, v19, v6
    v_dot2_f32_bf16 v7, v108, v12, 0
    v_dot2_f32_bf16 v7, v109, v13, v7
    v_dot2_f32_bf16 v7, v110, v14, v7
    v_dot2_f32_bf16 v7, v111, v15, v7
    v_dot2_f32_bf16 v7, v112, v16, v7
    v_dot2_f32_bf16 v7, v113, v17, v7
    v_dot2_f32_bf16 v7, v114, v18, v7
    v_dot2_f32_bf16 v7, v115, v19, v7
    v_add_f32_dpp v6, v6, v6 quad_perm:[1,0,3,2] row_mask:0xf bank_mask:0xf
    s_nop 1
    v_add_f32_dpp v7, v7, v7 quad_perm:[1,0,3,2] row_mask:0xf bank_mask:0xf
    v_add_f32_dpp v6, v6, v6 quad_perm:[2,3,0,1] row_mask:0xf bank_mask:0xf
    s_nop 0
    v_add_f32_dpp v7, v7, v7 quad_perm:[2,3,0,1] row_mask:0xf bank_mask:0xf
    v_add_f32_dpp v6, v6, v6 row_half_mirror row_mask:0xf bank_mask:0xf
    s_nop 0
    v_add_f32_dpp v7, v7, v7 row_half_mirror row_mask:0xf bank_mask:0xf
    v_add_f32_dpp v6, v6, v6 row_mirror row_mask:0xf bank_mask:0xf
    s_nop 0
    v_add_f32_dpp v7, v7, v7 row_mirror row_mask:0xf bank_mask:0xf
    v_cvt_pk_bf16_f32 v8, v6, v7
    ds_write_b32 v230, v8 offset:32
    v_lshlrev_b32 v6, 16, v8
    v_and_b32 v7, 0xffff0000, v8
    v_max3_f32 v3, v6, v7, v3
    v_dot2_f32_bf16 v6, v116, v12, 0
    v_dot2_f32_bf16 v6, v117, v13, v6
    v_dot2_f32_bf16 v6, v118, v14, v6
    v_dot2_f32_bf16 v6, v119, v15, v6
    v_dot2_f32_bf16 v6, v120, v16, v6
    v_dot2_f32_bf16 v6, v121, v17, v6
    v_dot2_f32_bf16 v6, v122, v18, v6
    v_dot2_f32_bf16 v6, v123, v19, v6
    v_dot2_f32_bf16 v7, v124, v12, 0
    v_dot2_f32_bf16 v7, v125, v13, v7
    v_dot2_f32_bf16 v7, v126, v14, v7
    v_dot2_f32_bf16 v7, v127, v15, v7
    v_dot2_f32_bf16 v7, v128, v16, v7
    v_dot2_f32_bf16 v7, v129, v17, v7
    v_dot2_f32_bf16 v7, v130, v18, v7
    v_dot2_f32_bf16 v7, v131, v19, v7
    v_add_f32_dpp v6, v6, v6 quad_perm:[1,0,3,2] row_mask:0xf bank_mask:0xf
    s_nop 1
    v_add_f32_dpp v7, v7, v7 quad_perm:[1,0,3,2] row_mask:0xf bank_mask:0xf
    v_add_f32_dpp v6, v6, v6 quad_perm:[2,3,0,1] row_mask:0xf bank_mask:0xf
    s_nop 0
    v_add_f32_dpp v7, v7, v7 quad_perm:[2,3,0,1] row_mask:0xf bank_mask:0xf
    v_add_f32_dpp v6, v6, v6 row_half_mirror row_mask:0xf bank_mask:0xf
    s_nop 0
    v_add_f32_dpp v7, v7, v7 row_half_mirror row_mask:0xf bank_mask:0xf
    v_add_f32_dpp v6, v6, v6 row_mirror row_mask:0xf bank_mask:0xf
    s_nop 0
    v_add_f32_dpp v7, v7, v7 row_mirror row_mask:0xf bank_mask:0xf
    v_cvt_pk_bf16_f32 v8, v6, v7
    ds_write_b32 v230, v8 offset:48
    v_lshlrev_b32 v6, 16, v8
    v_and_b32 v7, 0xffff0000, v8
    v_max3_f32 v3, v6, v7, v3
    s_cmp_eq_u32 s60, 1
    s_cbranch_scc1 L_kdone
    v_dot2_f32_bf16 v6, v132, v12, 0
    v_dot2_f32_bf16 v6, v133, v13, v6
    v_dot2_f32_bf16 v6, v134, v14, v6
    v_dot2_f32_bf16 v6, v135, v15, v6
    v_dot2_f32_bf16 v6, v136, v16, v6
    v_dot2_f32_bf16 v6, v137, v17, v6
    v_dot2_f32_bf16 v6, v138, v18, v6
    v_dot2_f32_bf16 v6, v139, v19, v6
    v_dot2_f32_bf16 v7, v140, v12, 0
    v_dot2_f32_bf16 v7, v141, v13, v7
    v_dot2_f32_bf16 v7, v142, v14, v7
    v_dot2_f32_bf16 v7, v143, v15, v7
    v_dot2_f32_bf16 v7, v144, v16, v7
    v_dot2_f32_bf16 v7, v145, v17, v7
    v_dot2_f32_bf16 v7, v146, v18, v7
    v_dot2_f32_bf16 v7, v147, v19, v7
    v_add_f32_dpp v6, v6, v6 quad_perm:[1,0,3,2] row_mask:0xf bank_mask:0xf
    s_nop 1
    v_add_f32_dpp v7, v7, v7 quad_perm:[1,0,3,2] row_mask:0xf bank_mask:0xf
    v_add_f32_dpp v6, v6, v6 quad_perm:[2,3,0,1] row_mask:0xf bank_mask:0xf
    s_nop 0
    v_add_f32_dpp v7, v7, v7 quad_perm:[2,3,0,1] row_mask:0xf bank_mask:0xf
    v_add_f32_dpp v6, v6, v6 row_half_mirror row_mask:0xf bank_mask:0xf
    s_nop 0
    v_add_f32_dpp v7, v7, v7 row_half_mirror row_mask:0xf bank_mask:0xf
    v_add_f32_dpp v6, v6, v6 row_mirror row_mask:0xf bank_mask:0xf
    s_nop 0
    v_add_f32_dpp v7, v7, v7 row_mirror row_mask:0xf bank_mask:0xf
    v_cvt_pk_bf16_f32 v8, v6, v7
    ds_write_b32 v230, v8 offset:64
    v_lshlrev_b32 v6, 16, v8
    v_and_b32 v7, 0xffff0000, v8
    v_max3_f32 v3, v6, v7, v3
    v_dot2_f32_bf16 v6, v148, v12, 0
    v_dot2_f32_bf16 v6, v149, v13, v6
    v_dot2_f32_bf16 v6, v150, v14, v6
    v_dot2_f32_bf16 v6, v151, v15, v6
    v_dot2_f32_bf16 v6, v152, v16, v6
    v_dot2_f32_bf16 v6, v153, v17, v6
    v_dot2_f32_bf16 v6, v154, v18, v6
    v_dot2_f32_bf16 v6, v155, v19, v6
    v_dot2_f32_bf16 v7, v156, v12, 0
    v_dot2_f32_bf16 v7, v157, v13, v7
    v_dot2_f32_bf16 v7, v158, v14, v7
    v_dot2_f32_bf16 v7, v159, v15, v7
    v_dot2_f32_bf16 v7, v160, v16, v7
    v_dot2_f32_bf16 v7, v161, v17, v7
    v_dot2_f32_bf16 v7, v162, v18, v7
    v_dot2_f32_bf16 v7, v163, v19, v7
    v_add_f32_dpp v6, v6, v6 quad_perm:[1,0,3,2] row_mask:0xf bank_mask:0xf
    s_nop 1
    v_add_f32_dpp v7, v7, v7 quad_perm:[1,0,3,2] row_mask:0xf bank_mask:0xf
    v_add_f32_dpp v6, v6, v6 quad_perm:[2,3,0,1] row_mask:0xf bank_mask:0xf
    s_nop 0
    v_add_f32_dpp v7, v7, v7 quad_perm:[2,3,0,1] row_mask:0xf bank_mask:0xf
    v_add_f32_dpp v6, v6, v6 row_half_mirror row_mask:0xf bank_mask:0xf
    s_nop 0
    v_add_f32_dpp v7, v7, v7 row_half_mirror row_mask:0xf bank_mask:0xf
    v_add_f32_dpp v6, v6, v6 row_mirror row_mask:0xf bank_mask:0xf
    s_nop 0
    v_add_f32_dpp v7, v7, v7 row_mirror row_mask:0xf bank_mask:0xf
    v_cvt_pk_bf16_f32 v8, v6, v7
    ds_write_b32 v230, v8 offset:80
    v_lshlrev_b32 v6, 16, v8
    v_and_b32 v7, 0xffff0000, v8
    v_max3_f32 v3, v6, v7, v3
    s_cmp_eq_u32 s60, 2
    s_cbranch_scc1 L_kdone
    v_dot2_f32_bf16 v6, v164, v12, 0
    v_dot2_f32_bf16 v6, v165, v13, v6
    v_dot2_f32_bf16 v6, v166, v14, v6
    v_dot2_f32_bf16 v6, v167, v15, v6
    v_dot2_f32_bf16 v6, v168, v16, v6
    v_dot2_f32_bf16 v6, v169, v17, v6
    v_dot2_f32_bf16 v6, v170, v18, v6
    v_dot2_f32_bf16 v6, v171, v19, v6
    v_dot2_f32_bf16 v7, v172, v12, 0
    v_dot2_f32_bf16 v7, v173, v13, v7
    v_dot2_f32_bf16 v7, v174, v14, v7
    v_dot2_f32_bf16 v7, v175, v15, v7
    v_dot2_f32_bf16 v7, v176, v16, v7
    v_dot2_f32_bf16 v7, v177, v17, v7
    v_dot2_f32_bf16 v7, v178, v18, v7
    v_dot2_f32_bf16 v7, v179, v19, v7
    v_add_f32_dpp v6, v6, v6 quad_perm:[1,0,3,2] row_mask:0xf bank_mask:0xf
    s_nop 1
    v_add_f32_dpp v7, v7, v7 quad_perm:[1,0,3,2] row_mask:0xf bank_mask:0xf
    v_add_f32_dpp v6, v6, v6 quad_perm:[2,3,0,1] row_mask:0xf bank_mask:0xf
    s_nop 0
    v_add_f32_dpp v7, v7, v7 quad_perm:[2,3,0,1] row_mask:0xf bank_mask:0xf
    v_add_f32_dpp v6, v6, v6 row_half_mirror row_mask:0xf bank_mask:0xf
    s_nop 0
    v_add_f32_dpp v7, v7, v7 row_half_mirror row_mask:0xf bank_mask:0xf
    v_add_f32_dpp v6, v6, v6 row_mirror row_mask:0xf bank_mask:0xf
    s_nop 0
    v_add_f32_dpp v7, v7, v7 row_mirror row_mask:0xf bank_mask:0xf
    v_cvt_pk_bf16_f32 v8, v6, v7
    ds_write_b32 v230, v8 offset:96
    v_lshlrev_b32 v6, 16, v8
    v_and_b32 v7, 0xffff0000, v8
    v_max3_f32 v3, v6, v7, v3
    v_dot2_f32_bf16 v6, v180, v12, 0
    v_dot2_f32_bf16 v6, v181, v13, v6
    v_dot2_f32_bf16 v6, v182, v14, v6
    v_dot2_f32_bf16 v6, v183, v15, v6
    v_dot2_f32_bf16 v6, v184, v16, v6
    v_dot2_f32_bf16 v6, v185, v17, v6
    v_dot2_f32_bf16 v6, v186, v18, v6
    v_dot2_f32_bf16 v6, v187, v19, v6
    v_dot2_f32_bf16 v7, v188, v12, 0
    v_dot2_f32_bf16 v7, v189, v13, v7
    v_dot2_f32_bf16 v7, v190, v14, v7
    v_dot2_f32_bf16 v7, v191, v15, v7
    v_dot2_f32_bf16 v7, v192, v16, v7
    v_dot2_f32_bf16 v7, v193, v17, v7
    v_dot2_f32_bf16 v7, v194, v18, v7
    v_dot2_f32_bf16 v7, v195, v19, v7
    v_add_f32_dpp v6, v6, v6 quad_perm:[1,0,3,2] row_mask:0xf bank_mask:0xf
    s_nop 1
    v_add_f32_dpp v7, v7, v7 quad_perm:[1,0,3,2] row_mask:0xf bank_mask:0xf
    v_add_f32_dpp v6, v6, v6 quad_perm:[2,3,0,1] row_mask:0xf bank_mask:0xf
    s_nop 0
    v_add_f32_dpp v7, v7, v7 quad_perm:[2,3,0,1] row_mask:0xf bank_mask:0xf
    v_add_f32_dpp v6, v6, v6 row_half_mirror row_mask:0xf bank_mask:0xf
    s_nop 0
    v_add_f32_dpp v7, v7, v7 row_half_mirror row_mask:0xf bank_mask:0xf
    v_add_f32_dpp v6, v6, v6 row_mirror row_mask:0xf bank_mask:0xf
    s_nop 0
    v_add_f32_dpp v7, v7, v7 row_mirror row_mask:0xf bank_mask:0xf
    v_cvt_pk_bf16_f32 v8, v6, v7
    ds_write_b32 v230, v8 offset:112
    v_lshlrev_b32 v6, 16, v8
    v_and_b32 v7, 0xffff0000, v8
    v_max3_f32 v3, v6, v7, v3
    s_cmp_eq_u32 s60, 3
    s_cbranch_scc1 L_kdone
    v_dot2_f32_bf16 v6, v196, v12, 0
    v_dot2_f32_bf16 v6, v197, v13, v6
    v_dot2_f32_bf16 v6, v198, v14, v6
    v_dot2_f32_bf16 v6, v199, v15, v6
    v_dot2_f32_bf16 v6, v200, v16, v6
    v_dot2_f32_bf16 v6, v201, v17, v6
    v_dot2_f32_bf16 v6, v202, v18, v6
    v_dot2_f32_bf16 v6, v203, v19, v6
    v_dot2_f32_bf16 v7, v204, v12, 0
    v_dot2_f32_bf16 v7, v205, v13, v7
    v_dot2_f32_bf16 v7, v206, v14, v7
    v_dot2_f32_bf16 v7, v207, v15, v7
    v_dot2_f32_bf16 v7, v208, v16, v7
    v_dot2_f32_bf16 v7, v209, v17, v7
    v_dot2_f32_bf16 v7, v210, v18, v7
    v_dot2_f32_bf16 v7, v211, v19, v7
    v_add_f32_dpp v6, v6, v6 quad_perm:[1,0,3,2] row_mask:0xf bank_mask:0xf
    s_nop 1
    v_add_f32_dpp v7, v7, v7 quad_perm:[1,0,3,2] row_mask:0xf bank_mask:0xf
    v_add_f32_dpp v6, v6, v6 quad_perm:[2,3,0,1] row_mask:0xf bank_mask:0xf
    s_nop 0
    v_add_f32_dpp v7, v7, v7 quad_perm:[2,3,0,1] row_mask:0xf bank_mask:0xf
    v_add_f32_dpp v6, v6, v6 row_half_mirror row_mask:0xf bank_mask:0xf
    s_nop 0
    v_add_f32_dpp v7, v7, v7 row_half_mirror row_mask:0xf bank_mask:0xf
    v_add_f32_dpp v6, v6, v6 row_mirror row_mask:0xf bank_mask:0xf
    s_nop 0
    v_add_f32_dpp v7, v7, v7 row_mirror row_mask:0xf bank_mask:0xf
    v_cvt_pk_bf16_f32 v8, v6, v7
    ds_write_b32 v230, v8 offset:128
    v_lshlrev_b32 v6, 16, v8
    v_and_b32 v7, 0xffff0000, v8
    v_max3_f32 v3, v6, v7, v3
    v_dot2_f32_bf16 v6, v212, v12, 0
    v_dot2_f32_bf16 v6, v213, v13, v6
    v_dot2_f32_bf16 v6, v214, v14, v6
    v_dot2_f32_bf16 v6, v215, v15, v6
    v_dot2_f32_bf16 v6, v216, v16, v6
    v_dot2_f32_bf16 v6, v217, v17, v6
    v_dot2_f32_bf16 v6, v218, v18, v6
    v_dot2_f32_bf16 v6, v219, v19, v6
    v_dot2_f32_bf16 v7, v220, v12, 0
    v_dot2_f32_bf16 v7, v221, v13, v7
    v_dot2_f32_bf16 v7, v222, v14, v7
    v_dot2_f32_bf16 v7, v223, v15, v7
    v_dot2_f32_bf16 v7, v224, v16, v7
    v_dot2_f32_bf16 v7, v225, v17, v7
    v_dot2_f32_bf16 v7, v226, v18, v7
    v_dot2_f32_bf16 v7, v227, v19, v7
    v_add_f32_dpp v6, v6, v6 quad_perm:[1,0,3,2] row_mask:0xf bank_mask:0xf
    s_nop 1
    v_add_f32_dpp v7, v7, v7 quad_perm:[1,0,3,2] row_mask:0xf bank_mask:0xf
    v_add_f32_dpp v6, v6, v6 quad_perm:[2,3,0,1] row_mask:0xf bank_mask:0xf
    s_nop 0
    v_add_f32_dpp v7, v7, v7 quad_perm:[2,3,0,1] row_mask:0xf bank_mask:0xf
    v_add_f32_dpp v6, v6, v6 row_half_mirror row_mask:0xf bank_mask:0xf
    s_nop 0
    v_add_f32_dpp v7, v7, v7 row_half_mirror row_mask:0xf bank_mask:0xf
    v_add_f32_dpp v6, v6, v6 row_mirror row_mask:0xf bank_mask:0xf
    s_nop 0
    v_add_f32_dpp v7, v7, v7 row_mirror row_mask:0xf bank_mask:0xf
    v_cvt_pk_bf16_f32 v8, v6, v7
    ds_write_b32 v230, v8 offset:144
    v_lshlrev_b32 v6, 16, v8
    v_and_b32 v7, 0xffff0000, v8
    v_max3_f32 v3, v6, v7, v3
L_kdone:
    s_mov_b32 s60, 0
    s_branch L_k0
L_kl0:
    s_mov_b32 s42, 0
    s_waitcnt lgkmcnt(0)
    s_cmp_lt_u32 s101, 60
    s_cselect_b32 s39, s39, -1
    s_cmp_ge_u32 s39, 96
    s_cbranch_scc1 L_kz0
    s_and_b32 s62, s39, 15
    s_lshl_b32 s62, s62, 21
    s_lshr_b32 s39, s39, 4
    s_lshl_b32 s39, s39, 15
    s_add_u32 s62, s62, s39
    s_add_u32 s50, s62, s100
    s_mov_b32 m0, s101
    s_add_u32 s101, s101, 1
    s_cmp_ge_u32 s101, 60
    s_cbranch_scc1 L_kc0
    s_mov_b32 s39, 1
    s_atomic_add s39, s[24:25], s87 glc
L_kc0:
    v_writelane_b32 v231, s50, m0
    s_branch L_kn0
L_kz0:
    s_mov_b64 s[88:89], s[32:33]
    s_mov_b64 s[92:93], s[32:33]
    s_mov_b32 s49, s36
    s_add_u32 s97, s36, 16384
    s_add_u32 s50, s36, 32768
    s_mov_b32 s37, 1
    s_branch L_kb0
L_k2v0:
    v_mov_b32 v8, v3
    v_mov_b32 v9, v3
    s_nop 1
    v_permlane16_swap_b32 v3, v9
    v_max_f32 v3, v3, v9
    v_mov_b32 v9, v3
    s_nop 1
    v_permlane32_swap_b32 v3, v9
    v_max_f32 v3, v3, v9
    v_mul_f32 v4, s47, v3
    v_sub_f32 v4, 0, v4
    s_mov_b32 s37, 0
    s_add_u32 s42, s101, 53
    s_branch L_vt0
L_vl0:
    s_mov_b64 s[88:89], s[28:29]
    s_mov_b32 s42, 0
    s_cmp_gt_i32 s42, 0
    s_cbranch_scc1 L_j1
    s_waitcnt lgkmcnt(0)
    s_and_b32 s46, s43, 15
    s_lshl_b32 s46, s46, 7
    s_lshr_b32 s41, s43, 4
    s_add_u32 s41, s41, s46
    s_lshl_b32 s41, s41, 2
    s_add_u32 s41, s41, s45
    s_mov_b32 s42, 1
    s_cmp_lt_u32 s43, 128
    s_cselect_b32 s41, s41, 8192
    s_cmp_lt_u32 s41, 8192
    s_cselect_b32 s42, s42, 1000
L_j1:
    s_cmp_lg_u32 s42, 1
    s_cbranch_scc1 L_n2
    s_mov_b32 s43, 1
    s_atomic_add s43, s[24:25], s44 glc
L_n2:
    s_lshl_b32 s46, s41, 12
    s_add_u32 s46, s46, s40
    s_cmp_lt_u32 s41, 8192
    s_cselect_b32 s49, s46, 0x80000000
    s_add_u32 s41, s41, s51
    s_sub_i32 s42, s42, 1
    s_mov_b32 s97, s49
    s_mov_b32 s37, 1
    s_branch L_vb0
L_kl1:
    s_mov_b32 s42, 0
    s_waitcnt lgkmcnt(0)
    s_cmp_lt_u32 s101, 60
    s_cselect_b32 s39, s39, -1
    s_cmp_ge_u32 s39, 96
    s_cbranch_scc1 L_kz1
    s_and_b32 s62, s39, 15
    s_lshl_b32 s62, s62, 21
    s_lshr_b32 s39, s39, 4
    s_lshl_b32 s39, s39, 15
    s_add_u32 s62, s62, s39
    s_add_u32 s50, s62, s100
    s_mov_b32 m0, s101
    s_add_u32 s101, s101, 1
    s_cmp_ge_u32 s101, 60
    s_cbranch_scc1 L_kc1
    s_mov_b32 s39, 1
    s_atomic_add s39, s[24:25], s87 glc
L_kc1:
    v_writelane_b32 v231, s50, m0
    s_branch L_kn1
L_kz1:
    s_mov_b64 s[88:89], s[32:33]
    s_mov_b64 s[92:93], s[32:33]
    s_mov_b32 s48, s36
    s_add_u32 s96, s36, 16384
    s_add_u32 s50, s36, 32768
    s_mov_b32 s37, 1
    s_branch L_kb1
L_k2v1:
    v_mov_b32 v8, v3
    v_mov_b32 v9, v3
    s_nop 1
    v_permlane16_swap_b32 v3, v9
    v_max_f32 v3, v3, v9
    v_mov_b32 v9, v3
    s_nop 1
    v_permlane32_swap_b32 v3, v9
    v_max_f32 v3, v3, v9
    v_mul_f32 v4, s47, v3
    v_sub_f32 v4, 0, v4
    s_mov_b32 s37, 0
    s_add_u32 s42, s101, 53
    s_branch L_vt1
L_vl1:
    s_mov_b64 s[88:89], s[28:29]
    s_mov_b32 s42, 0
    s_cmp_gt_i32 s42, 0
    s_cbranch_scc1 L_j3
    s_waitcnt lgkmcnt(0)
    s_and_b32 s46, s43, 15
    s_lshl_b32 s46, s46, 7
    s_lshr_b32 s41, s43, 4
    s_add_u32 s41, s41, s46
    s_lshl_b32 s41, s41, 2
    s_add_u32 s41, s41, s45
    s_mov_b32 s42, 1
    s_cmp_lt_u32 s43, 128
    s_cselect_b32 s41, s41, 8192
    s_cmp_lt_u32 s41, 8192
    s_cselect_b32 s42, s42, 1000
L_j3:
    s_cmp_lg_u32 s42, 1
    s_cbranch_scc1 L_n4
    s_mov_b32 s43, 1
    s_atomic_add s43, s[24:25], s44 glc
L_n4:
    s_lshl_b32 s46, s41, 12
    s_add_u32 s46, s46, s40
    s_cmp_lt_u32 s41, 8192
    s_cselect_b32 s48, s46, 0x80000000
    s_add_u32 s41, s41, s51
    s_sub_i32 s42, s42, 1
    s_mov_b32 s96, s48
    s_mov_b32 s37, 1
    s_branch L_vb1
.p2align 6
L_vt0:
    ds_read_b32 v228, v230
    ds_read_b32 v229, v230 offset:16
    v_add_u32 v230, 32, v230
    s_waitcnt lgkmcnt(0)
L_v0:
    s_sub_u32 s42, s42, 1
    s_cbranch_scc1 L_vl0
    s_cmp_lg_u32 s42, 0
    s_cbranch_scc1 L_vn0
    s_mov_b32 s43, 1
    s_atomic_add s43, s[24:25], s44 glc
L_vn0:
    s_sub_u32 s62, s101, s42
    s_sub_u32 s62, s62, 1
    s_and_b32 s62, s62, 63
    v_readlane_b32 s62, v231, s62
    s_cmp_lt_u32 s42, s101
    s_cselect_b32 s50, s62, s50
    s_mov_b32 s49, s50
    s_add_u32 s97, s50, 16384
    s_add_u32 s50, s50, 32768
L_vb0:
    v_lshlrev_b32 v6, 16, v228
    v_and_b32 v7, 0xffff0000, v228
    v_fma_f32 v6, v6, s47, v4
    v_fma_f32 v7, v7, s47, v4
    v_exp_f32 v6, v6
    v_exp_f32 v7, v7
    v_cvt_pk_bf16_f32 v8, v6, 0
    v_cvt_pk_bf16_f32 v9, 0, v6
    v_cvt_pk_bf16_f32 v10, v7, 0
    v_cvt_pk_bf16_f32 v11, 0, v7
    v_add_f32 v5, v5, v6
    v_add_f32 v5, v5, v7
    s_waitcnt vmcnt(7)
    buffer_load_dwordx4 v[68:71], v1, s[88:91], s49 offen offset:0 nt
    v_dot2c_f32_bf16 v20, v36, v8
    v_dot2c_f32_bf16 v21, v36, v9
    v_dot2c_f32_bf16 v22, v37, v8
    v_dot2c_f32_bf16 v23, v37, v9
    v_dot2c_f32_bf16 v24, v38, v8
    v_dot2c_f32_bf16 v25, v38, v9
    v_dot2c_f32_bf16 v26, v39, v8
    v_dot2c_f32_bf16 v27, v39, v9
    s_waitcnt vmcnt(7)
    buffer_load_dwordx4 v[72:75], v1, s[88:91], s49 offen offset:256 nt
    v_dot2c_f32_bf16 v28, v40, v8
    v_dot2c_f32_bf16 v29, v40, v9
    v_dot2c_f32_bf16 v30, v41, v8
    v_dot2c_f32_bf16 v31, v41, v9
    v_dot2c_f32_bf16 v32, v42, v8
    v_dot2c_f32_bf16 v33, v42, v9
    v_dot2c_f32_bf16 v34, v43, v8
    v_dot2c_f32_bf16 v35, v43, v9
    s_waitcnt vmcnt(7)
    buffer_load_dwordx4 v[76:79], v1, s[88:91], s49 offen offset:2048 nt
    v_dot2c_f32_bf16 v20, v44, v10
    v_dot2c_f32_bf16 v21, v44, v11
    v_dot2c_f32_bf16 v22, v45, v10
    v_dot2c_f32_bf16 v23, v45, v11
    v_dot2c_f32_bf16 v24, v46, v10
    v_dot2c_f32_bf16 v25, v46, v11
    v_dot2c_f32_bf16 v26, v47, v10
    v_dot2c_f32_bf16 v27, v47, v11
    s_waitcnt vmcnt(7)
    buffer_load_dwordx4 v[80:83], v1, s[88:91], s49 offen offset:2304 nt
    v_dot2c_f32_bf16 v28, v48, v10
    v_dot2c_f32_bf16 v29, v48, v11
    v_dot2c_f32_bf16 v30, v49, v10
    v_dot2c_f32_bf16 v31, v49, v11
    v_dot2c_f32_bf16 v32, v50, v10
    v_dot2c_f32_bf16 v33, v50, v11
    v_dot2c_f32_bf16 v34, v51, v10
    v_dot2c_f32_bf16 v35, v51, v11
    v_lshlrev_b32 v6, 16, v229
    v_and_b32 v7, 0xffff0000, v229
    v_fma_f32 v6, v6, s47, v4
    v_fma_f32 v7, v7, s47, v4
    v_exp_f32 v6, v6
    v_exp_f32 v7, v7
    v_cvt_pk_bf16_f32 v8, v6, 0
    v_cvt_pk_bf16_f32 v9, 0, v6
    v_cvt_pk_bf16_f32 v10, v7, 0
    v_cvt_pk_bf16_f32 v11, 0, v7
    v_add_f32 v5, v5, v6
    v_add_f32 v5, v5, v7
    s_waitcnt vmcnt(7)
    buffer_load_dwordx4 v[84:87], v1, s[92:95], s97 offen offset:0 nt
    v_dot2c_f32_bf16 v20, v52, v8
    v_dot2c_f32_bf16 v21, v52, v9
    v_dot2c_f32_bf16 v22, v53, v8
    v_dot2c_f32_bf16 v23, v53, v9
    v_dot2c_f32_bf16 v24, v54, v8
    v_dot2c_f32_bf16 v25, v54, v9
    v_dot2c_f32_bf16 v26, v55, v8
    v_dot2c_f32_bf16 v27, v55, v9
    s_waitcnt vmcnt(7)
    buffer_load_dwordx4 v[88:91], v1, s[92:95], s97 offen offset:256 nt
    v_dot2c_f32_bf16 v28, v56, v8
    v_dot2c_f32_bf16 v29, v56, v9
    v_dot2c_f32_bf16 v30, v57, v8
    v_dot2c_f32_bf16 v31, v57, v9
    v_dot2c_f32_bf16 v32, v58, v8
    v_dot2c_f32_bf16 v33, v58, v9
    v_dot2c_f32_bf16 v34, v59, v8
    v_dot2c_f32_bf16 v35, v59, v9
    s_waitcnt vmcnt(7)
    buffer_load_dwordx4 v[92:95], v1, s[92:95], s97 offen offset:2048 nt
    v_dot2c_f32_bf16 v20, v60, v10
    v_dot2c_f32_bf16 v21, v60, v11
    v_dot2c_f32_bf16 v22, v61, v10
    v_dot2c_f32_bf16 v23, v61, v11
    v_dot2c_f32_bf16 v24, v62, v10
    v_dot2c_f32_bf16 v25, v62, v11
    v_dot2c_f32_bf16 v26, v63, v10
    v_dot2c_f32_bf16 v27, v63, v11
    s_waitcnt vmcnt(7)
    buffer_load_dwordx4 v[96:99], v1, s[92:95], s97 offen offset:2304 nt
    v_dot2c_f32_bf16 v28, v64, v10
    v_dot2c_f32_bf16 v29, v64, v11
    v_dot2c_f32_bf16 v30, v65, v10
    v_dot2c_f32_bf16 v31, v65, v11
    v_dot2c_f32_bf16 v32, v66, v10
    v_dot2c_f32_bf16 v33, v66, v11
    v_dot2c_f32_bf16 v34, v67, v10
    v_dot2c_f32_bf16 v35, v67, v11
    s_cmp_lg_u32 s37, 0
    s_cbranch_scc1 L_body1
L_vt1:
    ds_read_b32 v228, v230
    ds_read_b32 v229, v230 offset:16
    v_add_u32 v230, 32, v230
    s_waitcnt lgkmcnt(0)
L_v1:
    s_sub_u32 s42, s42, 1
    s_cbranch_scc1 L_vl1
    s_cmp_lg_u32 s42, 0
    s_cbranch_scc1 L_vn1
    s_mov_b32 s43, 1
    s_atomic_add s43, s[24:25], s44 glc
L_vn1:
    s_sub_u32 s62, s101, s42
    s_sub_u32 s62, s62, 1
    s_and_b32 s62, s62, 63
    v_readlane_b32 s62, v231, s62
    s_cmp_lt_u32 s42, s101
    s_cselect_b32 s50, s62, s50
    s_mov_b32 s48, s50
    s_add_u32 s96, s50, 16384
    s_add_u32 s50, s50, 32768
L_vb1:
    v_lshlrev_b32 v6, 16, v228
    v_and_b32 v7, 0xffff0000, v228
    v_fma_f32 v6, v6, s47, v4
    v_fma_f32 v7, v7, s47, v4
    v_exp_f32 v6, v6
    v_exp_f32 v7, v7
    v_cvt_pk_bf16_f32 v8, v6, 0
    v_cvt_pk_bf16_f32 v9, 0, v6
    v_cvt_pk_bf16_f32 v10, v7, 0
    v_cvt_pk_bf16_f32 v11, 0, v7
    v_add_f32 v5, v5, v6
    v_add_f32 v5, v5, v7
    s_waitcnt vmcnt(7)
    buffer_load_dwordx4 v[36:39], v1, s[88:91], s48 offen offset:0 nt
    v_dot2c_f32_bf16 v20, v68, v8
    v_dot2c_f32_bf16 v21, v68, v9
    v_dot2c_f32_bf16 v22, v69, v8
    v_dot2c_f32_bf16 v23, v69, v9
    v_dot2c_f32_bf16 v24, v70, v8
    v_dot2c_f32_bf16 v25, v70, v9
    v_dot2c_f32_bf16 v26, v71, v8
    v_dot2c_f32_bf16 v27, v71, v9
    s_waitcnt vmcnt(7)
    buffer_load_dwordx4 v[40:43], v1, s[88:91], s48 offen offset:256 nt
    v_dot2c_f32_bf16 v28, v72, v8
    v_dot2c_f32_bf16 v29, v72, v9
    v_dot2c_f32_bf16 v30, v73, v8
    v_dot2c_f32_bf16 v31, v73, v9
    v_dot2c_f32_bf16 v32, v74, v8
    v_dot2c_f32_bf16 v33, v74, v9
    v_dot2c_f32_bf16 v34, v75, v8
    v_dot2c_f32_bf16 v35, v75, v9
    s_waitcnt vmcnt(7)
    buffer_load_dwordx4 v[44:47], v1, s[88:91], s48 offen offset:2048 nt
    v_dot2c_f32_bf16 v20, v76, v10
    v_dot2c_f32_bf16 v21, v76, v11
    v_dot2c_f32_bf16 v22, v77, v10
    v_dot2c_f32_bf16 v23, v77, v11
    v_dot2c_f32_bf16 v24, v78, v10
    v_dot2c_f32_bf16 v25, v78, v11
    v_dot2c_f32_bf16 v26, v79, v10
    v_dot2c_f32_bf16 v27, v79, v11
    s_waitcnt vmcnt(7)
    buffer_load_dwordx4 v[48:51], v1, s[88:91], s48 offen offset:2304 nt
    v_dot2c_f32_bf16 v28, v80, v10
    v_dot2c_f32_bf16 v29, v80, v11
    v_dot2c_f32_bf16 v30, v81, v10
    v_dot2c_f32_bf16 v31, v81, v11
    v_dot2c_f32_bf16 v32, v82, v10
    v_dot2c_f32_bf16 v33, v82, v11
    v_dot2c_f32_bf16 v34, v83, v10
    v_dot2c_f32_bf16 v35, v83, v11
    v_lshlrev_b32 v6, 16, v229
    v_and_b32 v7, 0xffff0000, v229
    v_fma_f32 v6, v6, s47, v4
    v_fma_f32 v7, v7, s47, v4
    v_exp_f32 v6, v6
    v_exp_f32 v7, v7
    v_cvt_pk_bf16_f32 v8, v6, 0
    v_cvt_pk_bf16_f32 v9, 0, v6
    v_cvt_pk_bf16_f32 v10, v7, 0
    v_cvt_pk_bf16_f32 v11, 0, v7
    v_add_f32 v5, v5, v6
    v_add_f32 v5, v5, v7
    s_waitcnt vmcnt(7)
    buffer_load_dwordx4 v[52:55], v1, s[92:95], s96 offen offset:0 nt
    v_dot2c_f32_bf16 v20, v84, v8
    v_dot2c_f32_bf16 v21, v84, v9
    v_dot2c_f32_bf16 v22, v85, v8
    v_dot2c_f32_bf16 v23, v85, v9
    v_dot2c_f32_bf16 v24, v86, v8
    v_dot2c_f32_bf16 v25, v86, v9
    v_dot2c_f32_bf16 v26, v87, v8
    v_dot2c_f32_bf16 v27, v87, v9
    s_waitcnt vmcnt(7)
    buffer_load_dwordx4 v[56:59], v1, s[92:95], s96 offen offset:256 nt
    v_dot2c_f32_bf16 v28, v88, v8
    v_dot2c_f32_bf16 v29, v88, v9
    v_dot2c_f32_bf16 v30, v89, v8
    v_dot2c_f32_bf16 v31, v89, v9
    v_dot2c_f32_bf16 v32, v90, v8
    v_dot2c_f32_bf16 v33, v90, v9
    v_dot2c_f32_bf16 v34, v91, v8
    v_dot2c_f32_bf16 v35, v91, v9
    s_waitcnt vmcnt(7)
    buffer_load_dwordx4 v[60:63], v1, s[92:95], s96 offen offset:2048 nt
    v_dot2c_f32_bf16 v20, v92, v10
    v_dot2c_f32_bf16 v21, v92, v11
    v_dot2c_f32_bf16 v22, v93, v10
    v_dot2c_f32_bf16 v23, v93, v11
    v_dot2c_f32_bf16 v24, v94, v10
    v_dot2c_f32_bf16 v25, v94, v11
    v_dot2c_f32_bf16 v26, v95, v10
    v_dot2c_f32_bf16 v27, v95, v11
    s_waitcnt vmcnt(7)
    buffer_load_dwordx4 v[64:67], v1, s[92:95], s96 offen offset:2304 nt
    v_dot2c_f32_bf16 v28, v96, v10
    v_dot2c_f32_bf16 v29, v96, v11
    v_dot2c_f32_bf16 v30, v97, v10
    v_dot2c_f32_bf16 v31, v97, v11
    v_dot2c_f32_bf16 v32, v98, v10
    v_dot2c_f32_bf16 v33, v98, v11
    v_dot2c_f32_bf16 v34, v99, v10
    v_dot2c_f32_bf16 v35, v99, v11
    s_cmp_lg_u32 s37, 0
    s_cbranch_scc1 L_body0
    s_branch L_vt0
.p2align 6
L_loop:
L_body0:
    s_cmp_ge_u32 s48, 0x80000000
    s_cbranch_scc1 L_sdone
    s_cmp_gt_i32 s42, 0
    s_cbranch_scc1 L_j5
    s_waitcnt lgkmcnt(0)
    s_and_b32 s46, s43, 15
    s_lshl_b32 s46, s46, 7
    s_lshr_b32 s41, s43, 4
    s_add_u32 s41, s41, s46
    s_lshl_b32 s41, s41, 2
    s_add_u32 s41, s41, s45
    s_mov_b32 s42, 1
    s_cmp_lt_u32 s43, 128
    s_cselect_b32 s41, s41, 8192
    s_cmp_lt_u32 s41, 8192
    s_cselect_b32 s42, s42, 1000
L_j5:
    s_cmp_lg_u32 s42, 1
    s_cbranch_scc1 L_n6
    s_mov_b32 s43, 1
    s_atomic_add s43, s[24:25], s44 glc
L_n6:
    s_lshl_b32 s46, s41, 12
    s_add_u32 s46, s46, s40
    s_cmp_lt_u32 s41, 8192
    s_cselect_b32 s49, s46, 0x80000000
    s_add_u32 s41, s41, s51
    s_sub_i32 s42, s42, 1
    s_waitcnt vmcnt(7)
    buffer_load_dwordx4 v[68:71], v1, s[28:31], s49 offen offset:0 nt
    v_dot2_f32_bf16 v6, v36, v12, 0
    v_dot2_f32_bf16 v6, v37, v13, v6
    v_dot2_f32_bf16 v6, v38, v14, v6
    v_dot2_f32_bf16 v6, v39, v15, v6
    s_waitcnt vmcnt(7)
    buffer_load_dwordx4 v[72:75], v1, s[28:31], s49 offen offset:256 nt
    v_dot2_f32_bf16 v6, v40, v16, v6
    v_dot2_f32_bf16 v6, v41, v17, v6
    v_dot2_f32_bf16 v6, v42, v18, v6
    v_dot2_f32_bf16 v6, v43, v19, v6
    s_waitcnt vmcnt(7)
    buffer_load_dwordx4 v[76:79], v1, s[28:31], s49 offen offset:2048 nt
    v_dot2_f32_bf16 v7, v44, v12, 0
    v_dot2_f32_bf16 v7, v45, v13, v7
    v_dot2_f32_bf16 v7, v46, v14, v7
    v_dot2_f32_bf16 v7, v47, v15, v7
    s_waitcnt vmcnt(7)
    buffer_load_dwordx4 v[80:83], v1, s[28:31], s49 offen offset:2304 nt
    v_dot2_f32_bf16 v7, v48, v16, v7
    v_dot2_f32_bf16 v7, v49, v17, v7
    v_dot2_f32_bf16 v7, v50, v18, v7
    v_dot2_f32_bf16 v7, v51, v19, v7
    v_add_f32_dpp v6, v6, v6 quad_perm:[1,0,3,2] row_mask:0xf bank_mask:0xf
    s_nop 1
    v_add_f32_dpp v7, v7, v7 quad_perm:[1,0,3,2] row_mask:0xf bank_mask:0xf
    v_add_f32_dpp v6, v6, v6 quad_perm:[2,3,0,1] row_mask:0xf bank_mask:0xf
    s_nop 0
    v_add_f32_dpp v7, v7, v7 quad_perm:[2,3,0,1] row_mask:0xf bank_mask:0xf
    v_add_f32_dpp v6, v6, v6 row_half_mirror row_mask:0xf bank_mask:0xf
    s_nop 0
    v_add_f32_dpp v7, v7, v7 row_half_mirror row_mask:0xf bank_mask:0xf
    v_add_f32_dpp v6, v6, v6 row_mirror row_mask:0xf bank_mask:0xf
    s_nop 0
    v_add_f32_dpp v7, v7, v7 row_mirror row_mask:0xf bank_mask:0xf
    v_cvt_pk_bf16_f32 v8, v6, v7
    v_lshlrev_b32 v6, 16, v8
    v_and_b32 v7, 0xffff0000, v8
    v_max_f32 v8, v6, v7
    v_cmp_gt_f32 vcc, v8, v3
    s_cbranch_vccnz L_rare7
L_back8:
    v_fma_f32 v6, v6, s47, v4
    v_fma_f32 v7, v7, s47, v4
    v_exp_f32 v6, v6
    v_exp_f32 v7, v7
    v_cvt_pk_bf16_f32 v8, v6, 0
    v_cvt_pk_bf16_f32 v9, 0, v6
    v_cvt_pk_bf16_f32 v10, v7, 0
    v_cvt_pk_bf16_f32 v11, 0, v7
    v_add_f32 v5, v5, v6
    v_add_f32 v5, v5, v7
    s_waitcnt vmcnt(7)
    buffer_load_dwordx4 v[84:87], v1, s[32:35], s49 offen offset:0 nt
    v_dot2c_f32_bf16 v20, v52, v8
    v_dot2c_f32_bf16 v21, v52, v9
    v_dot2c_f32_bf16 v22, v53, v8
    v_dot2c_f32_bf16 v23, v53, v9
    v_dot2c_f32_bf16 v24, v54, v8
    v_dot2c_f32_bf16 v25, v54, v9
    v_dot2c_f32_bf16 v26, v55, v8
    v_dot2c_f32_bf16 v27, v55, v9
    s_waitcnt vmcnt(7)
    buffer_load_dwordx4 v[88:91], v1, s[32:35], s49 offen offset:256 nt
    v_dot2c_f32_bf16 v28, v56, v8
    v_dot2c_f32_bf16 v29, v56, v9
    v_dot2c_f32_bf16 v30, v57, v8
    v_dot2c_f32_bf16 v31, v57, v9
    v_dot2c_f32_bf16 v32, v58, v8
    v_dot2c_f32_bf16 v33, v58, v9
    v_dot2c_f32_bf16 v34, v59, v8
    v_dot2c_f32_bf16 v35, v59, v9
    s_waitcnt vmcnt(7)
    buffer_load_dwordx4 v[92:95], v1, s[32:35], s49 offen offset:2048 nt
    v_dot2c_f32_bf16 v20, v60, v10
    v_dot2c_f32_bf16 v21, v60, v11
    v_dot2c_f32_bf16 v22, v61, v10
    v_dot2c_f32_bf16 v23, v61, v11
    v_dot2c_f32_bf16 v24, v62, v10
    v_dot2c_f32_bf16 v25, v62, v11
    v_dot2c_f32_bf16 v26, v63, v10
    v_dot2c_f32_bf16 v27, v63, v11
    s_waitcnt vmcnt(7)
    buffer_load_dwordx4 v[96:99], v1, s[32:35], s49 offen offset:2304 nt
    v_dot2c_f32_bf16 v28, v64, v10
    v_dot2c_f32_bf16 v29, v64, v11
    v_dot2c_f32_bf16 v30, v65, v10
    v_dot2c_f32_bf16 v31, v65, v11
    v_dot2c_f32_bf16 v32, v66, v10
    v_dot2c_f32_bf16 v33, v66, v11
    v_dot2c_f32_bf16 v34, v67, v10
    v_dot2c_f32_bf16 v35, v67, v11
L_body1:
    s_cmp_ge_u32 s49, 0x80000000
    s_cbranch_scc1 L_sdone
    s_cmp_gt_i32 s42, 0
    s_cbranch_scc1 L_j9
    s_waitcnt lgkmcnt(0)
    s_and_b32 s46, s43, 15
    s_lshl_b32 s46, s46, 7
    s_lshr_b32 s41, s43, 4
    s_add_u32 s41, s41, s46
    s_lshl_b32 s41, s41, 2
    s_add_u32 s41, s41, s45
    s_mov_b32 s42, 1
    s_cmp_lt_u32 s43, 128
    s_cselect_b32 s41, s41, 8192
    s_cmp_lt_u32 s41, 8192
    s_cselect_b32 s42, s42, 1000
L_j9:
    s_cmp_lg_u32 s42, 1
    s_cbranch_scc1 L_n10
    s_mov_b32 s43, 1
    s_atomic_add s43, s[24:25], s44 glc
L_n10:
    s_lshl_b32 s46, s41, 12
    s_add_u32 s46, s46, s40
    s_cmp_lt_u32 s41, 8192
    s_cselect_b32 s48, s46, 0x80000000
    s_add_u32 s41, s41, s51
    s_sub_i32 s42, s42, 1
    s_waitcnt vmcnt(7)
    buffer_load_dwordx4 v[36:39], v1, s[28:31], s48 offen offset:0 nt
    v_dot2_f32_bf16 v6, v68, v12, 0
    v_dot2_f32_bf16 v6, v69, v13, v6
    v_dot2_f32_bf16 v6, v70, v14, v6
    v_dot2_f32_bf16 v6, v71, v15, v6
    s_waitcnt vmcnt(7)
    buffer_load_dwordx4 v[40:43], v1, s[28:31], s48 offen offset:256 nt
    v_dot2_f32_bf16 v6, v72, v16, v6
    v_dot2_f32_bf16 v6, v73, v17, v6
    v_dot2_f32_bf16 v6, v74, v18, v6
    v_dot2_f32_bf16 v6, v75, v19, v6
    s_waitcnt vmcnt(7)
    buffer_load_dwordx4 v[44:47], v1, s[28:31], s48 offen offset:2048 nt
    v_dot2_f32_bf16 v7, v76, v12, 0
    v_dot2_f32_bf16 v7, v77, v13, v7
    v_dot2_f32_bf16 v7, v78, v14, v7
    v_dot2_f32_bf16 v7, v79, v15, v7
    s_waitcnt vmcnt(7)
    buffer_load_dwordx4 v[48:51], v1, s[28:31], s48 offen offset:2304 nt
    v_dot2_f32_bf16 v7, v80, v16, v7
    v_dot2_f32_bf16 v7, v81, v17, v7
    v_dot2_f32_bf16 v7, v82, v18, v7
    v_dot2_f32_bf16 v7, v83, v19, v7
    v_add_f32_dpp v6, v6, v6 quad_perm:[1,0,3,2] row_mask:0xf bank_mask:0xf
    s_nop 1
    v_add_f32_dpp v7, v7, v7 quad_perm:[1,0,3,2] row_mask:0xf bank_mask:0xf
    v_add_f32_dpp v6, v6, v6 quad_perm:[2,3,0,1] row_mask:0xf bank_mask:0xf
    s_nop 0
    v_add_f32_dpp v7, v7, v7 quad_perm:[2,3,0,1] row_mask:0xf bank_mask:0xf
    v_add_f32_dpp v6, v6, v6 row_half_mirror row_mask:0xf bank_mask:0xf
    s_nop 0
    v_add_f32_dpp v7, v7, v7 row_half_mirror row_mask:0xf bank_mask:0xf
    v_add_f32_dpp v6, v6, v6 row_mirror row_mask:0xf bank_mask:0xf
    s_nop 0
    v_add_f32_dpp v7, v7, v7 row_mirror row_mask:0xf bank_mask:0xf
    v_cvt_pk_bf16_f32 v8, v6, v7
    v_lshlrev_b32 v6, 16, v8
    v_and_b32 v7, 0xffff0000, v8
    v_max_f32 v8, v6, v7
    v_cmp_gt_f32 vcc, v8, v3
    s_cbranch_vccnz L_rare11
L_back12:
    v_fma_f32 v6, v6, s47, v4
    v_fma_f32 v7, v7, s47, v4
    v_exp_f32 v6, v6
    v_exp_f32 v7, v7
    v_cvt_pk_bf16_f32 v8, v6, 0
    v_cvt_pk_bf16_f32 v9, 0, v6
    v_cvt_pk_bf16_f32 v10, v7, 0
    v_cvt_pk_bf16_f32 v11, 0, v7
    v_add_f32 v5, v5, v6
    v_add_f32 v5, v5, v7
    s_waitcnt vmcnt(7)
    buffer_load_dwordx4 v[52:55], v1, s[32:35], s48 offen offset:0 nt
    v_dot2c_f32_bf16 v20, v84, v8
    v_dot2c_f32_bf16 v21, v84, v9
    v_dot2c_f32_bf16 v22, v85, v8
    v_dot2c_f32_bf16 v23, v85, v9
    v_dot2c_f32_bf16 v24, v86, v8
    v_dot2c_f32_bf16 v25, v86, v9
    v_dot2c_f32_bf16 v26, v87, v8
    v_dot2c_f32_bf16 v27, v87, v9
    s_waitcnt vmcnt(7)
    buffer_load_dwordx4 v[56:59], v1, s[32:35], s48 offen offset:256 nt
    v_dot2c_f32_bf16 v28, v88, v8
    v_dot2c_f32_bf16 v29, v88, v9
    v_dot2c_f32_bf16 v30, v89, v8
    v_dot2c_f32_bf16 v31, v89, v9
    v_dot2c_f32_bf16 v32, v90, v8
    v_dot2c_f32_bf16 v33, v90, v9
    v_dot2c_f32_bf16 v34, v91, v8
    v_dot2c_f32_bf16 v35, v91, v9
    s_waitcnt vmcnt(7)
    buffer_load_dwordx4 v[60:63], v1, s[32:35], s48 offen offset:2048 nt
    v_dot2c_f32_bf16 v20, v92, v10
    v_dot2c_f32_bf16 v21, v92, v11
    v_dot2c_f32_bf16 v22, v93, v10
    v_dot2c_f32_bf16 v23, v93, v11
    v_dot2c_f32_bf16 v24, v94, v10
    v_dot2c_f32_bf16 v25, v94, v11
    v_dot2c_f32_bf16 v26, v95, v10
    v_dot2c_f32_bf16 v27, v95, v11
    s_waitcnt vmcnt(7)
    buffer_load_dwordx4 v[64:67], v1, s[32:35], s48 offen offset:2304 nt
    v_dot2c_f32_bf16 v28, v96, v10
    v_dot2c_f32_bf16 v29, v96, v11
    v_dot2c_f32_bf16 v30, v97, v10
    v_dot2c_f32_bf16 v31, v97, v11
    v_dot2c_f32_bf16 v32, v98, v10
    v_dot2c_f32_bf16 v33, v98, v11
    v_dot2c_f32_bf16 v34, v99, v10
    v_dot2c_f32_bf16 v35, v99, v11
    s_cmp_eq_u32 s60, 0
    s_cbranch_scc1 L_loop
L_bdone:
    s_mov_b32 s60, 0
    s_branch L_loop
L_rare7:
    v_mov_b32 v9, v8
    s_nop 1
    v_permlane16_swap_b32 v8, v9
    v_max_f32 v8, v8, v9
    v_mov_b32 v9, v8
    s_nop 1
    v_permlane32_swap_b32 v8, v9
    v_max_f32 v8, v8, v9
    v_max_f32 v8, v8, v3
    v_mul_f32 v4, s47, v8
    v_sub_f32 v4, 0, v4
    v_fma_f32 v9, v3, s47, v4
    v_exp_f32 v9, v9
    v_mov_b32 v3, v8
    v_mul_f32 v5, v5, v9
    v_pk_mul_f32 v[20:21], v[20:21], v[8:9] op_sel:[0,1] op_sel_hi:[1,1]
    v_pk_mul_f32 v[22:23], v[22:23], v[8:9] op_sel:[0,1] op_sel_hi:[1,1]
    v_pk_mul_f32 v[24:25], v[24:25], v[8:9] op_sel:[0,1] op_sel_hi:[1,1]
    v_pk_mul_f32 v[26:27], v[26:27], v[8:9] op_sel:[0,1] op_sel_hi:[1,1]
    v_pk_mul_f32 v[28:29], v[28:29], v[8:9] op_sel:[0,1] op_sel_hi:[1,1]
    v_pk_mul_f32 v[30:31], v[30:31], v[8:9] op_sel:[0,1] op_sel_hi:[1,1]
    v_pk_mul_f32 v[32:33], v[32:33], v[8:9] op_sel:[0,1] op_sel_hi:[1,1]
    v_pk_mul_f32 v[34:35], v[34:35], v[8:9] op_sel:[0,1] op_sel_hi:[1,1]
    s_branch L_back8
L_rare11:
    v_mov_b32 v9, v8
    s_nop 1
    v_permlane16_swap_b32 v8, v9
    v_max_f32 v8, v8, v9
    v_mov_b32 v9, v8
    s_nop 1
    v_permlane32_swap_b32 v8, v9
    v_max_f32 v8, v8, v9
    v_max_f32 v8, v8, v3
    v_mul_f32 v4, s47, v8
    v_sub_f32 v4, 0, v4
    v_fma_f32 v9, v3, s47, v4
    v_exp_f32 v9, v9
    v_mov_b32 v3, v8
    v_mul_f32 v5, v5, v9
    v_pk_mul_f32 v[20:21], v[20:21], v[8:9] op_sel:[0,1] op_sel_hi:[1,1]
    v_pk_mul_f32 v[22:23], v[22:23], v[8:9] op_sel:[0,1] op_sel_hi:[1,1]
    v_pk_mul_f32 v[24:25], v[24:25], v[8:9] op_sel:[0,1] op_sel_hi:[1,1]
    v_pk_mul_f32 v[26:27], v[26:27], v[8:9] op_sel:[0,1] op_sel_hi:[1,1]
    v_pk_mul_f32 v[28:29], v[28:29], v[8:9] op_sel:[0,1] op_sel_hi:[1,1]
    v_pk_mul_f32 v[30:31], v[30:31], v[8:9] op_sel:[0,1] op_sel_hi:[1,1]
    v_pk_mul_f32 v[32:33], v[32:33], v[8:9] op_sel:[0,1] op_sel_hi:[1,1]
    v_pk_mul_f32 v[34:35], v[34:35], v[8:9] op_sel:[0,1] op_sel_hi:[1,1]
    s_branch L_back12
L_sdone:
    v_mov_b32 v8, 520
    ds_write_b32 v8, v8
    s_lshr_b32 s55, s54, 4
    s_lshr_b32 s62, s54, 8
    s_lshr_b32 s63, s54, 12
    v_permlane32_swap_b32 v20, v28
    v_permlane32_swap_b32 v21, v29
    v_permlane32_swap_b32 v22, v30
    v_permlane32_swap_b32 v23, v31
    v_permlane32_swap_b32 v24, v32
    v_permlane32_swap_b32 v25, v33
    v_permlane32_swap_b32 v26, v34
    v_permlane32_swap_b32 v27, v35
    v_mov_b32 v8, v5
    v_add_f32 v20, v20, v28
    v_add_f32 v21, v21, v29
    v_add_f32 v22, v22, v30
    v_add_f32 v23, v23, v31
    v_add_f32 v24, v24, v32
    v_add_f32 v25, v25, v33
    v_add_f32 v26, v26, v34
    v_add_f32 v27, v27, v35
    v_permlane16_swap_b32 v5, v8
    v_permlane16_swap_b32 v20, v24
    v_permlane16_swap_b32 v21, v25
    v_permlane16_swap_b32 v22, v26
    v_permlane16_swap_b32 v23, v27
    v_add_f32 v5, v5, v8
    v_add_f32 v20, v20, v24
    v_add_f32 v21, v21, v25
    v_add_f32 v22, v22, v26
    v_add_f32 v23, v23, v27
    v_mov_b32 v8, v5
    v_bfi_b32 v20, 15, s54, v20
    v_bfi_b32 v21, 15, s55, v21
    v_bfi_b32 v22, 15, s62, v22
    v_bfi_b32 v23, 15, s63, v23
    v_permlane32_swap_b32 v5, v8
    buffer_store_dwordx4 v[20:23], v2, s[56:59], s52 offen sc1
    v_add_f32 v9, v5, v8
    v_mov_b32 v8, v3
    v_mov_b32 v10, s54
    v_mov_b32 v11, s54
    s_mov_b64 exec, 1
    buffer_store_dwordx4 v[8:11], off, s[56:59], s53 sc1
    s_barrier
    s_endpgm
L_helper:
    s_setprio 3
    v_mov_b32 v160, 0
    v_mov_b32 v161, 0
    v_mov_b32 v165, 512
    v_lshlrev_b32 v154, 4, v0
    v_mov_b32 v162, 0
    v_mov_b32 v163, 0
    ds_write_b128 v165, v[160:163]
    v_lshrrev_b32 v156, 3, v0
    v_mul_u32_u24 v157, 28, v156
    v_mul_u32_u24 v158, 114688, v156
    v_and_b32 v159, 7, v0
    v_lshl_add_u32 v158, v159, 4, v158
    s_lshr_b32 s61, s27, 2
    s_mul_i32 s60, s61, 224
    s_mul_i32 s62, s61, 917504
    s_lshl_b32 s63, s26, 9
    s_add_u32 s62, s62, s63
    s_and_b32 s63, s27, 3
    s_lshl_b32 s63, s63, 7
    s_add_u32 s62, s62, s63
    s_lshl_b32 s93, s26, 12
    s_cmp_lg_u32 s27, 0
    s_waitcnt lgkmcnt(0)
    s_load_dword s52, s[24:25], 229376
    s_mov_b32 s56, s24
    s_mov_b32 s57, s25
    s_mov_b32 s58, 4194304
    s_mov_b32 s59, 0x20000
    s_cbranch_scc1 L_noclr13
    v_lshlrev_b32 v160, 8, v0
    s_lshl_b32 s61, s26, 14
    s_add_u32 s61, s61, 3145728
    buffer_store_dword v161, v160, s[56:59], s61 offen sc1
    s_mov_b64 exec, -1
L_noclr13:
    s_mov_b32 s28, s4
    s_mov_b32 s29, s5
    s_mov_b32 s30, 896
    s_mov_b32 s31, 0x20000
    s_mov_b32 s32, s10
    s_mov_b32 s33, s11
    s_mov_b32 s34, 3670016
    s_mov_b32 s35, 0x20000
    buffer_load_dwordx4 v[8:11], v154, s[28:31], 0 offen
    buffer_load_dwordx4 v[24:27], v157, s[28:31], s60 offen
    buffer_load_dwordx3 v[28:30], v157, s[28:31], s60 offen offset:16
    buffer_load_dwordx4 v[48:51], v158, s[32:35], s62 offen nt
    s_add_u32 s62, s62, 8192
    buffer_load_dwordx4 v[52:55], v158, s[32:35], s62 offen nt
    s_add_u32 s62, s62, 8192
    buffer_load_dwordx4 v[56:59], v158, s[32:35], s62 offen nt
    s_add_u32 s62, s62, 8192
    buffer_load_dwordx4 v[60:63], v158, s[32:35], s62 offen nt
    s_add_u32 s62, s62, 8192
    buffer_load_dwordx4 v[64:67], v158, s[32:35], s62 offen nt
    s_add_u32 s62, s62, 8192
    buffer_load_dwordx4 v[68:71], v158, s[32:35], s62 offen nt
    s_add_u32 s62, s62, 8192
    buffer_load_dwordx4 v[72:75], v158, s[32:35], s62 offen nt
    s_add_u32 s62, s62, 8192
    buffer_load_dwordx4 v[76:79], v158, s[32:35], s62 offen nt
    s_add_u32 s62, s62, 8192
    buffer_load_dwordx4 v[80:83], v158, s[32:35], s62 offen nt
    s_add_u32 s62, s62, 8192
    buffer_load_dwordx4 v[84:87], v158, s[32:35], s62 offen nt
    s_add_u32 s62, s62, 8192
    buffer_load_dwordx4 v[88:91], v158, s[32:35], s62 offen nt
    s_add_u32 s62, s62, 8192
    buffer_load_dwordx4 v[92:95], v158, s[32:35], s62 offen nt
    s_add_u32 s62, s62, 8192
    buffer_load_dwordx4 v[96:99], v158, s[32:35], s62 offen nt
    s_add_u32 s62, s62, 8192
    buffer_load_dwordx4 v[100:103], v158, s[32:35], s62 offen nt
    s_barrier
    v_mov_b32 v144, 15
    v_mov_b32 v147, 0x3ff
    v_mov_b32 v32, 0
    v_mov_b32 v33, 0
    v_mov_b32 v34, 0
    v_mov_b32 v35, 0
    v_mov_b32 v36, 0
    v_mov_b32 v37, 0
    v_mov_b32 v38, 0
    v_mov_b32 v39, 0
    v_lshlrev_b32 v151, 5, v159
    v_lshrrev_b32 v160, 5, v0
    v_lshl_add_u32 v151, v160, 4, v151
    v_and_b32 v160, 1, v3
    v_lshl_add_u32 v151, v160, 3, v151
    s_lshl_b32 s60, s2, 8
    v_lshlrev_b32 v146, 3, v160
    s_mov_b32 s90, 0x05040100
    s_mov_b32 s91, 0x07060302
    s_mov_b32 s62, 991054117
    s_mov_b32 s63, 1138753536
    s_mov_b32 s88, -1
    s_mov_b32 s89, 0x00ffffff
    s_mov_b32 s99, 200000
    s_waitcnt vmcnt(14)
    v_lshlrev_b32 v16, 16, v8
    v_and_b32 v17, 0xffff0000, v8
    v_lshlrev_b32 v18, 16, v9
    v_and_b32 v19, 0xffff0000, v9
    v_lshlrev_b32 v20, 16, v10
    v_and_b32 v21, 0xffff0000, v10
    v_lshlrev_b32 v22, 16, v11
    v_and_b32 v23, 0xffff0000, v11
    v_pk_add_f32 v[160:161], v[16:17], v[18:19]
    v_pk_add_f32 v[162:163], v[20:21], v[22:23]
    v_pk_add_f32 v[160:161], v[160:161], v[162:163]
    v_add_f32 v156, v160, v161
    s_nop 1
    v_add_f32_dpp v156, v156, v156 quad_perm:[1,0,3,2] row_mask:0xf bank_mask:0xf
    v_lshlrev_b32 v112, 16, v24
    v_and_b32 v113, 0xffff0000, v24
    v_add_f32_dpp v156, v156, v156 quad_perm:[2,3,0,1] row_mask:0xf bank_mask:0xf
    v_lshlrev_b32 v114, 16, v25
    v_and_b32 v115, 0xffff0000, v25
    v_add_f32_dpp v156, v156, v156 row_half_mirror row_mask:0xf bank_mask:0xf
    v_lshlrev_b32 v116, 16, v26
    v_and_b32 v117, 0xffff0000, v26
    v_add_f32_dpp v156, v156, v156 row_mirror row_mask:0xf bank_mask:0xf
    v_lshlrev_b32 v118, 16, v27
    v_and_b32 v119, 0xffff0000, v27
    v_mov_b32 v157, v156
    v_lshlrev_b32 v120, 16, v28
    v_and_b32 v121, 0xffff0000, v28
    v_permlane16_swap_b32 v156, v157
    v_lshlrev_b32 v122, 16, v29
    v_and_b32 v123, 0xffff0000, v29
    v_add_f32 v156, v156, v157
    v_lshlrev_b32 v124, 16, v30
    v_and_b32 v125, 0xffff0000, v30
    v_mov_b32 v157, v156
    s_nop 1
    v_permlane32_swap_b32 v156, v157
    v_add_f32 v156, v156, v157
    v_mul_f32 v157, s62, v156
    v_fma_f32 v156, -v157, s63, v156
    v_fma_f32 v156, v156, s62, v157
    v_pk_add_f32 v[16:17], v[16:17], v[156:157] op_sel:[0,0] op_sel_hi:[1,0] neg_lo:[0,1] neg_hi:[0,1]
    v_pk_add_f32 v[18:19], v[18:19], v[156:157] op_sel:[0,0] op_sel_hi:[1,0] neg_lo:[0,1] neg_hi:[0,1]
    v_pk_add_f32 v[20:21], v[20:21], v[156:157] op_sel:[0,0] op_sel_hi:[1,0] neg_lo:[0,1] neg_hi:[0,1]
    v_pk_add_f32 v[22:23], v[22:23], v[156:157] op_sel:[0,0] op_sel_hi:[1,0] neg_lo:[0,1] neg_hi:[0,1]
    v_cvt_pk_bf16_f32 v148, v156, v156
    v_pk_mul_f32 v[160:161], v[16:17], v[16:17]
    v_pk_mul_f32 v[162:163], v[18:19], v[18:19]
    v_and_b32 v148, 0xffff0000, v148
    v_pk_fma_f32 v[160:161], v[20:21], v[20:21], v[160:161]
    v_pk_fma_f32 v[162:163], v[22:23], v[22:23], v[162:163]
    v_pk_add_f32 v[160:161], v[160:161], v[162:163]
    v_add_f32 v158, v160, v161
    v_cndmask_b32 v158, 0, v158, s[88:89]
    s_nop 1
    v_add_f32_dpp v158, v158, v158 quad_perm:[1,0,3,2] row_mask:0xf bank_mask:0xf
    v_pk_add_f32 v[112:113], v[112:113], v[148:149] op_sel:[0,0] op_sel_hi:[1,0] neg_lo:[0,1] neg_hi:[0,1]
    v_pk_add_f32 v[114:115], v[114:115], v[148:149] op_sel:[0,0] op_sel_hi:[1,0] neg_lo:[0,1] neg_hi:[0,1]
    v_add_f32_dpp v158, v158, v158 quad_perm:[2,3,0,1] row_mask:0xf bank_mask:0xf
    v_pk_add_f32 v[116:117], v[116:117], v[148:149] op_sel:[0,0] op_sel_hi:[1,0] neg_lo:[0,1] neg_hi:[0,1]
    v_pk_add_f32 v[118:119], v[118:119], v[148:149] op_sel:[0,0] op_sel_hi:[1,0] neg_lo:[0,1] neg_hi:[0,1]
    v_add_f32_dpp v158, v158, v158 row_half_mirror row_mask:0xf bank_mask:0xf
    v_pk_add_f32 v[120:121], v[120:121], v[148:149] op_sel:[0,0] op_sel_hi:[1,0] neg_lo:[0,1] neg_hi:[0,1]
    v_pk_add_f32 v[122:123], v[122:123], v[148:149] op_sel:[0,0] op_sel_hi:[1,0] neg_lo:[0,1] neg_hi:[0,1]
    v_add_f32_dpp v158, v158, v158 row_mirror row_mask:0xf bank_mask:0xf
    v_pk_add_f32 v[124:125], v[124:125], v[148:149] op_sel:[0,0] op_sel_hi:[1,0] neg_lo:[0,1] neg_hi:[0,1]
    v_cvt_pk_bf16_f32 v24, v112, v113
    v_mov_b32 v157, v158
    v_cvt_pk_bf16_f32 v25, v114, v115
    v_cvt_pk_bf16_f32 v26, v116, v117
    v_permlane16_swap_b32 v158, v157
    v_cvt_pk_bf16_f32 v27, v118, v119
    v_cvt_pk_bf16_f32 v28, v120, v121
    v_add_f32 v158, v158, v157
    v_cvt_pk_bf16_f32 v29, v122, v123
    v_cvt_pk_bf16_f32 v30, v124, v125
    v_mov_b32 v157, v158
    v_lshlrev_b32 v112, 16, v24
    v_and_b32 v113, 0xffff0000, v24
    v_permlane32_swap_b32 v158, v157
    v_lshlrev_b32 v114, 16, v25
    v_and_b32 v115, 0xffff0000, v25
    v_add_f32 v158, v158, v157
    v_lshlrev_b32 v116, 16, v26
    v_and_b32 v117, 0xffff0000, v26
    v_mul_f32 v157, s62, v158
    v_lshlrev_b32 v118, 16, v27
    v_and_b32 v119, 0xffff0000, v27
    v_fma_f32 v158, -v157, s63, v158
    v_lshlrev_b32 v120, 16, v28
    v_and_b32 v121, 0xffff0000, v28
    v_fma_f32 v158, v158, s62, v157
    v_lshlrev_b32 v122, 16, v29
    v_and_b32 v123, 0xffff0000, v29
    v_cvt_pk_bf16_f32 v158, v158, v158
    v_lshlrev_b32 v124, 16, v30
    v_and_b32 v125, 0xffff0000, v30
    v_and_b32 v158, 0xffff0000, v158
    v_add_f32 v158, 925353388, v158
    v_cvt_pk_bf16_f32 v158, v158, v158
    v_and_b32 v158, 0xffff0000, v158
    v_sqrt_f32 v158, v158
    s_nop 0
    v_cvt_pk_bf16_f32 v158, v158, v158
    v_and_b32 v158, 0xffff0000, v158
    v_rcp_f32 v160, v158
    s_nop 0
    v_mov_b32 v153, v160
    v_pk_mul_f32 v[112:113], v[112:113], v[160:161] op_sel:[0,0] op_sel_hi:[1,0]
    v_pk_mul_f32 v[114:115], v[114:115], v[160:161] op_sel:[0,0] op_sel_hi:[1,0]
    v_pk_mul_f32 v[116:117], v[116:117], v[160:161] op_sel:[0,0] op_sel_hi:[1,0]
    v_pk_mul_f32 v[118:119], v[118:119], v[160:161] op_sel:[0,0] op_sel_hi:[1,0]
    v_pk_mul_f32 v[120:121], v[120:121], v[160:161] op_sel:[0,0] op_sel_hi:[1,0]
    v_pk_mul_f32 v[122:123], v[122:123], v[160:161] op_sel:[0,0] op_sel_hi:[1,0]
    v_pk_mul_f32 v[124:125], v[124:125], v[160:161] op_sel:[0,0] op_sel_hi:[1,0]
    v_cvt_pk_bf16_f32 v24, v112, v113
    v_cvt_pk_bf16_f32 v25, v114, v115
    v_cvt_pk_bf16_f32 v26, v116, v117
    v_cvt_pk_bf16_f32 v27, v118, v119
    v_cvt_pk_bf16_f32 v28, v120, v121
    v_cvt_pk_bf16_f32 v29, v122, v123
    v_cvt_pk_bf16_f32 v30, v124, v125
    s_waitcnt lgkmcnt(0)
    s_add_u32 s52, s52, 0x11111111
    s_lshr_b32 s53, s52, 8
    s_lshr_b32 s54, s52, 16
    s_lshr_b32 s55, s52, 24
    s_lshr_b32 s100, s52, 4
    s_lshr_b32 s101, s52, 12
    v_lshrrev_b32 v145, v146, s52
    v_lshrrev_b32 v146, v146, s100
    s_waitcnt vmcnt(12)
    v_perm_b32 v156, v52, v48, s90
    v_perm_b32 v52, v52, v48, s91
    v_perm_b32 v157, v53, v49, s90
    v_perm_b32 v53, v53, v49, s91
    v_perm_b32 v158, v54, v50, s90
    v_perm_b32 v54, v54, v50, s91
    v_perm_b32 v159, v55, v51, s90
    v_perm_b32 v55, v55, v51, s91
    v_dot2c_f32_bf16 v32, v156, v24
    v_dot2c_f32_bf16 v33, v52, v24
    v_dot2c_f32_bf16 v34, v157, v24
    v_dot2c_f32_bf16 v35, v53, v24
    v_dot2c_f32_bf16 v36, v158, v24
    v_dot2c_f32_bf16 v37, v54, v24
    v_dot2c_f32_bf16 v38, v159, v24
    v_dot2c_f32_bf16 v39, v55, v24
    s_waitcnt vmcnt(10)
    v_perm_b32 v156, v60, v56, s90
    v_perm_b32 v60, v60, v56, s91
    v_perm_b32 v157, v61, v57, s90
    v_perm_b32 v61, v61, v57, s91
    v_perm_b32 v158, v62, v58, s90
    v_perm_b32 v62, v62, v58, s91
    v_perm_b32 v159, v63, v59, s90
    v_perm_b32 v63, v63, v59, s91
    v_dot2c_f32_bf16 v32, v156, v25
    v_dot2c_f32_bf16 v33, v60, v25
    v_dot2c_f32_bf16 v34, v157, v25
    v_dot2c_f32_bf16 v35, v61, v25
    v_dot2c_f32_bf16 v36, v158, v25
    v_dot2c_f32_bf16 v37, v62, v25
    v_dot2c_f32_bf16 v38, v159, v25
    v_dot2c_f32_bf16 v39, v63, v25
    s_waitcnt vmcnt(8)
    v_perm_b32 v156, v68, v64, s90
    v_perm_b32 v68, v68, v64, s91
    v_perm_b32 v157, v69, v65, s90
    v_perm_b32 v69, v69, v65, s91
    v_perm_b32 v158, v70, v66, s90
    v_perm_b32 v70, v70, v66, s91
    v_perm_b32 v159, v71, v67, s90
    v_perm_b32 v71, v71, v67, s91
    v_dot2c_f32_bf16 v32, v156, v26
    v_dot2c_f32_bf16 v33, v68, v26
    v_dot2c_f32_bf16 v34, v157, v26
    v_dot2c_f32_bf16 v35, v69, v26
    v_dot2c_f32_bf16 v36, v158, v26
    v_dot2c_f32_bf16 v37, v70, v26
    v_dot2c_f32_bf16 v38, v159, v26
    v_dot2c_f32_bf16 v39, v71, v26
    s_waitcnt vmcnt(6)
    v_perm_b32 v156, v76, v72, s90
    v_perm_b32 v76, v76, v72, s91
    v_perm_b32 v157, v77, v73, s90
    v_perm_b32 v77, v77, v73, s91
    v_perm_b32 v158, v78, v74, s90
    v_perm_b32 v78, v78, v74, s91
    v_perm_b32 v159, v79, v75, s90
    v_perm_b32 v79, v79, v75, s91
    v_dot2c_f32_bf16 v32, v156, v27
    v_dot2c_f32_bf16 v33, v76, v27
    v_dot2c_f32_bf16 v34, v157, v27
    v_dot2c_f32_bf16 v35, v77, v27
    v_dot2c_f32_bf16 v36, v158, v27
    v_dot2c_f32_bf16 v37, v78, v27
    v_dot2c_f32_bf16 v38, v159, v27
    v_dot2c_f32_bf16 v39, v79, v27
    s_waitcnt vmcnt(4)
    v_perm_b32 v156, v84, v80, s90
    v_perm_b32 v84, v84, v80, s91
    v_perm_b32 v157, v85, v81, s90
    v_perm_b32 v85, v85, v81, s91
    v_perm_b32 v158, v86, v82, s90
    v_perm_b32 v86, v86, v82, s91
    v_perm_b32 v159, v87, v83, s90
    v_perm_b32 v87, v87, v83, s91
    v_dot2c_f32_bf16 v32, v156, v28
    v_dot2c_f32_bf16 v33, v84, v28
    v_dot2c_f32_bf16 v34, v157, v28
    v_dot2c_f32_bf16 v35, v85, v28
    v_dot2c_f32_bf16 v36, v158, v28
    v_dot2c_f32_bf16 v37, v86, v28
    v_dot2c_f32_bf16 v38, v159, v28
    v_dot2c_f32_bf16 v39, v87, v28
    s_waitcnt vmcnt(2)
    v_perm_b32 v156, v92, v88, s90
    v_perm_b32 v92, v92, v88, s91
    v_perm_b32 v157, v93, v89, s90
    v_perm_b32 v93, v93, v89, s91
    v_perm_b32 v158, v94, v90, s90
    v_perm_b32 v94, v94, v90, s91
    v_perm_b32 v159, v95, v91, s90
    v_perm_b32 v95, v95, v91, s91
    v_dot2c_f32_bf16 v32, v156, v29
    v_dot2c_f32_bf16 v33, v92, v29
    v_dot2c_f32_bf16 v34, v157, v29
    v_dot2c_f32_bf16 v35, v93, v29
    v_dot2c_f32_bf16 v36, v158, v29
    v_dot2c_f32_bf16 v37, v94, v29
    v_dot2c_f32_bf16 v38, v159, v29
    v_dot2c_f32_bf16 v39, v95, v29
    s_waitcnt vmcnt(0)
    v_perm_b32 v156, v100, v96, s90
    v_perm_b32 v100, v100, v96, s91
    v_perm_b32 v157, v101, v97, s90
    v_perm_b32 v101, v101, v97, s91
    v_perm_b32 v158, v102, v98, s90
    v_perm_b32 v102, v102, v98, s91
    v_perm_b32 v159, v103, v99, s90
    v_perm_b32 v103, v103, v99, s91
    v_dot2c_f32_bf16 v32, v156, v30
    v_dot2c_f32_bf16 v33, v100, v30
    v_dot2c_f32_bf16 v34, v157, v30
    v_dot2c_f32_bf16 v35, v101, v30
    v_dot2c_f32_bf16 v36, v158, v30
    v_dot2c_f32_bf16 v37, v102, v30
    v_dot2c_f32_bf16 v38, v159, v30
    v_dot2c_f32_bf16 v39, v103, v30
    v_permlane32_swap_b32 v32, v36
    v_permlane32_swap_b32 v33, v37
    v_permlane32_swap_b32 v34, v38
    v_permlane32_swap_b32 v35, v39
    v_add_f32 v32, v32, v36
    v_add_f32 v33, v33, v37
    v_add_f32 v34, v34, v38
    v_add_f32 v35, v35, v39
    s_nop 0
    v_permlane16_swap_b32 v32, v34
    v_permlane16_swap_b32 v33, v35
    v_add_f32 v32, v32, v34
    v_add_f32 v33, v33, v35
    s_nop 0
    v_add_f32_dpp v32, v32, v32 row_ror:8 row_mask:0xf bank_mask:0xf
    v_add_f32_dpp v33, v33, v33 row_ror:8 row_mask:0xf bank_mask:0xf
    v_bfi_b32 v32, v144, v145, v32
    v_bfi_b32 v33, v144, v146, v33
    s_mov_b32 exec_lo, 0x00ff00ff
    s_mov_b32 exec_hi, 0x00ff00ff
    buffer_store_dwordx2 v[32:33], v151, s[56:59], s60 offen sc1
    s_mov_b64 exec, -1
    v_lshlrev_b32 v164, 3, v0
    v_mov_b32 v160, 1
    v_mov_b32 v161, s52
    buffer_load_dwordx4 v[48:51], v154, s[56:59], s93 offen offset:0 sc1
    buffer_load_dwordx4 v[52:55], v154, s[56:59], s93 offen offset:1024 sc1
    buffer_load_dwordx4 v[56:59], v154, s[56:59], s93 offen offset:2048 sc1
    buffer_load_dwordx4 v[60:63], v154, s[56:59], s93 offen offset:3072 sc1
    s_sleep 16
L_pq14:
    buffer_load_dwordx4 v[64:67], v154, s[56:59], s93 offen offset:0 sc1
    buffer_load_dwordx4 v[68:71], v154, s[56:59], s93 offen offset:1024 sc1
    buffer_load_dwordx4 v[72:75], v154, s[56:59], s93 offen offset:2048 sc1
    buffer_load_dwordx4 v[76:79], v154, s[56:59], s93 offen offset:3072 sc1
    s_waitcnt vmcnt(4)
    v_xor_b32 v156, s52, v48
    v_xor_b32 v157, s100, v49
    v_bitop3_b32 v156, v156, v50, s53 bitop3:0xf6
    v_bitop3_b32 v157, v157, v51, s101 bitop3:0xf6
    v_bitop3_b32 v156, v156, v52, s52 bitop3:0xf6
    v_bitop3_b32 v157, v157, v53, s100 bitop3:0xf6
    v_bitop3_b32 v156, v156, v54, s53 bitop3:0xf6
    v_bitop3_b32 v157, v157, v55, s101 bitop3:0xf6
    v_bitop3_b32 v156, v156, v56, s52 bitop3:0xf6
    v_bitop3_b32 v157, v157, v57, s100 bitop3:0xf6
    v_bitop3_b32 v156, v156, v58, s53 bitop3:0xf6
    v_bitop3_b32 v157, v157, v59, s101 bitop3:0xf6
    v_bitop3_b32 v156, v156, v60, s52 bitop3:0xf6
    v_bitop3_b32 v157, v157, v61, s100 bitop3:0xf6
    v_bitop3_b32 v156, v156, v62, s53 bitop3:0xf6
    v_bitop3_b32 v157, v157, v63, s101 bitop3:0xf6
    v_bitop3_b32 v156, v156, v157, v144 bitop3:0xa8
    v_cmp_ne_u32 vcc, 0, v156
    s_cbranch_vccz L_pqk16
    buffer_load_dwordx4 v[48:51], v154, s[56:59], s93 offen offset:0 sc1
    buffer_load_dwordx4 v[52:55], v154, s[56:59], s93 offen offset:1024 sc1
    buffer_load_dwordx4 v[56:59], v154, s[56:59], s93 offen offset:2048 sc1
    buffer_load_dwordx4 v[60:63], v154, s[56:59], s93 offen offset:3072 sc1
    s_waitcnt vmcnt(4)
    v_xor_b32 v156, s52, v64
    v_xor_b32 v157, s100, v65
    v_bitop3_b32 v156, v156, v66, s53 bitop3:0xf6
    v_bitop3_b32 v157, v157, v67, s101 bitop3:0xf6
    v_bitop3_b32 v156, v156, v68, s52 bitop3:0xf6
    v_bitop3_b32 v157, v157, v69, s100 bitop3:0xf6
    v_bitop3_b32 v156, v156, v70, s53 bitop3:0xf6
    v_bitop3_b32 v157, v157, v71, s101 bitop3:0xf6
    v_bitop3_b32 v156, v156, v72, s52 bitop3:0xf6
    v_bitop3_b32 v157, v157, v73, s100 bitop3:0xf6
    v_bitop3_b32 v156, v156, v74, s53 bitop3:0xf6
    v_bitop3_b32 v157, v157, v75, s101 bitop3:0xf6
    v_bitop3_b32 v156, v156, v76, s52 bitop3:0xf6
    v_bitop3_b32 v157, v157, v77, s100 bitop3:0xf6
    v_bitop3_b32 v156, v156, v78, s53 bitop3:0xf6
    v_bitop3_b32 v157, v157, v79, s101 bitop3:0xf6
    v_bitop3_b32 v156, v156, v157, v144 bitop3:0xa8
    v_cmp_ne_u32 vcc, 0, v156
    s_cbranch_vccz L_pqk17
    s_sub_u32 s99, s99, 1
    s_cbranch_scc0 L_pq14
    s_branch L_end
L_pqk16:
    v_pk_add_f32 v[112:113], v[48:49], v[52:53]
    v_pk_add_f32 v[120:121], v[56:57], v[60:61]
    v_pk_add_f32 v[114:115], v[50:51], v[54:55]
    v_pk_add_f32 v[122:123], v[58:59], v[62:63]
    s_branch L_pqo15
L_pqk17:
    v_pk_add_f32 v[112:113], v[64:65], v[68:69]
    v_pk_add_f32 v[120:121], v[72:73], v[76:77]
    v_pk_add_f32 v[114:115], v[66:67], v[70:71]
    v_pk_add_f32 v[122:123], v[74:75], v[78:79]
L_pqo15:
    v_pk_add_f32 v[112:113], v[112:113], v[120:121]
    v_pk_add_f32 v[114:115], v[114:115], v[122:123]
    v_cvt_pk_bf16_f32 v156, v112, v113
    v_cvt_pk_bf16_f32 v157, v114, v115
    ds_write_b64 v164, v[156:157]
    ds_write_b64 v165, v[160:161]
    s_setprio 0
    s_mov_b32 s36, s12
    s_mov_b32 s37, s13
    s_mov_b32 s38, 3670016
    s_mov_b32 s39, 0x20000
    s_mov_b32 s48, s20
    s_mov_b32 s49, s21
    s_mov_b32 s50, 896
    s_mov_b32 s51, 0x20000
    v_lshlrev_b32 v149, 13, v0
    v_lshlrev_b32 v152, 2, v0
    s_lshl_b32 s62, s2, 12
    s_add_u32 s86, s62, 2097152
    s_add_u32 s87, s62, 1048576
    s_lshr_b32 s61, s27, 2
    s_lshl_b32 s62, s26, 2
    s_and_b32 s63, s27, 3
    s_add_u32 s62, s62, s63
    s_mul_i32 s44, s61, 401408
    s_lshl_b32 s63, s62, 7
    s_add_u32 s44, s44, s63
    s_mul_i32 s45, s61, 7168
    s_lshl_b32 s63, s62, 8
    s_add_u32 s45, s45, s63
    s_add_u32 s45, s45, 131072
    s_sub_u32 s62, s26, 7
    s_mul_i32 s60, s27, 100352
    s_lshl_b32 s63, s62, 7
    s_add_u32 s60, s60, s63
    s_mul_i32 s61, s27, 1792
    s_lshl_b32 s63, s62, 8
    s_add_u32 s61, s61, s63
    s_add_u32 s61, s61, 163840
    s_cmp_lt_u32 s2, 112
    s_cselect_b32 s40, s16, s18
    s_cselect_b32 s41, s17, s19
    s_cselect_b32 s44, s44, s60
    s_cselect_b32 s45, s45, s61
    s_movk_i32 s46, 896
    s_cselect_b32 s46, 3584, s46
    s_cmp_lt_u32 s2, 224
    s_cselect_b32 s42, 1605632, 0
    s_mov_b32 s43, 0x20000
    s_cselect_b32 s45, s45, 0x80000000
    v_lshrrev_b32 v156, 3, v0
    v_mul_u32_u24 v157, 14, v156
    v_mul_u32_u24 v158, s46, v157
    v_and_b32 v159, 7, v0
    v_lshl_add_u32 v158, v159, 4, v158
    buffer_load_dwordx4 v[168:171], v158, s[40:43], s44 offen nt
    s_add_u32 s44, s44, s46
    buffer_load_dwordx4 v[172:175], v158, s[40:43], s44 offen nt
    s_add_u32 s44, s44, s46
    buffer_load_dwordx4 v[176:179], v158, s[40:43], s44 offen nt
    s_add_u32 s44, s44, s46
    buffer_load_dwordx4 v[180:183], v158, s[40:43], s44 offen nt
    s_add_u32 s44, s44, s46
    buffer_load_dwordx4 v[184:187], v158, s[40:43], s44 offen nt
    s_add_u32 s44, s44, s46
    buffer_load_dwordx4 v[188:191], v158, s[40:43], s44 offen nt
    s_add_u32 s44, s44, s46
    buffer_load_dwordx4 v[192:195], v158, s[40:43], s44 offen nt
    s_add_u32 s44, s44, s46
    buffer_load_dwordx4 v[196:199], v158, s[40:43], s44 offen nt
    s_add_u32 s44, s44, s46
    buffer_load_dwordx4 v[200:203], v158, s[40:43], s44 offen nt
    s_add_u32 s44, s44, s46
    buffer_load_dwordx4 v[204:207], v158, s[40:43], s44 offen nt
    s_add_u32 s44, s44, s46
    buffer_load_dwordx4 v[208:211], v158, s[40:43], s44 offen nt
    s_add_u32 s44, s44, s46
    buffer_load_dwordx4 v[212:215], v158, s[40:43], s44 offen nt
    s_add_u32 s44, s44, s46
    buffer_load_dwordx4 v[216:219], v158, s[40:43], s44 offen nt
    s_add_u32 s44, s44, s46
    buffer_load_dwordx4 v[220:223], v158, s[40:43], s44 offen nt
    s_lshl_b32 s96, s2, 4
    s_add_u32 s97, s96, 2101248
    s_add_u32 s96, s96, 2097152
    v_mov_b32 v32, 0
    v_mov_b32 v33, 0
    v_mov_b32 v34, 0
    v_mov_b32 v35, 0
    v_mov_b32 v36, 0
    v_mov_b32 v37, 0
    v_mov_b32 v38, 0
    v_mov_b32 v39, 0
    s_waitcnt vmcnt(0)
    v_lshlrev_b32 v162, 1, v157
    v_lshlrev_b32 v160, 1, v3
    s_lshl_b32 s89, s2, 3
    s_cmp_ge_u32 s2, 224
    s_cbranch_scc1 L_noz18
    s_cmp_lt_u32 s2, 112
    s_cbranch_scc1 L_r119
    s_mul_i32 s62, s27, 448
    s_add_u32 s62, s62, 131072
    s_add_u32 s63, s62, 14336
    v_min_u32 v161, 55, v0
    v_lshlrev_b32 v161, 3, v161
    v_add_u32 v163, 7168, v161
    v_and_b32 v155, 8, v161
    v_lshrrev_b32 v164, v155, s100
    v_lshrrev_b32 v155, v155, s52
L_ph20:
    buffer_load_dwordx2 v[112:113], v161, s[56:59], s62 offen sc1
    buffer_load_dwordx2 v[114:115], v163, s[56:59], s62 offen sc1
    buffer_load_dwordx2 v[116:117], v161, s[56:59], s63 offen sc1
    buffer_load_dwordx2 v[118:119], v163, s[56:59], s63 offen sc1
    s_waitcnt vmcnt(0)
    v_xor_b32 v156, v155, v112
    v_xor_b32 v157, v164, v113
    v_bitop3_b32 v156, v156, v114, v155 bitop3:0xf6
    v_bitop3_b32 v157, v157, v115, v164 bitop3:0xf6
    v_bitop3_b32 v156, v156, v116, v155 bitop3:0xf6
    v_bitop3_b32 v157, v157, v117, v164 bitop3:0xf6
    v_bitop3_b32 v156, v156, v118, v155 bitop3:0xf6
    v_bitop3_b32 v157, v157, v119, v164 bitop3:0xf6
    v_bitop3_b32 v156, v156, v157, v144 bitop3:0xa8
    v_cmp_ne_u32 vcc, 0, v156
    s_cbranch_vccz L_pho21
    s_sleep 32
    s_sub_u32 s99, s99, 1
    s_cbranch_scc0 L_ph20
    s_branch L_end
L_pho21:
    v_pk_add_f32 v[112:113], v[112:113], v[114:115]
    v_pk_add_f32 v[116:117], v[116:117], v[118:119]
    v_pk_add_f32 v[112:113], v[112:113], v[116:117]
    v_cvt_pk_bf16_f32 v112, v112, v112
    v_and_b32 v112, 0xffff0000, v112
    v_cvt_pk_bf16_f32 v113, v113, v113
    v_and_b32 v113, 0xffff0000, v113
    s_mov_b32 s62, 3216550459
    v_mul_f32 v156, s62, v112
    v_mul_f32 v157, s62, v113
    v_exp_f32 v156, v156
    v_exp_f32 v157, v157
    v_add_f32 v156, 1.0, v156
    v_add_f32 v157, 1.0, v157
    v_rcp_f32 v156, v156
    v_rcp_f32 v157, v157
    v_mul_f32 v112, v112, v156
    v_mul_f32 v113, v113, v157
    v_cvt_pk_bf16_f32 v112, v112, v113
    ds_bpermute_b32 v24, v162, v112 offset:0
    ds_bpermute_b32 v25, v162, v112 offset:4
    ds_bpermute_b32 v26, v162, v112 offset:8
    ds_bpermute_b32 v27, v162, v112 offset:12
    ds_bpermute_b32 v28, v162, v112 offset:16
    ds_bpermute_b32 v29, v162, v112 offset:20
    ds_bpermute_b32 v30, v162, v112 offset:24
    v_and_b32 v146, 1, v3
    v_lshlrev_b32 v146, 4, v146
    v_mov_b32 v144, 0xff
    v_lshrrev_b32 v145, v146, s52
    v_lshrrev_b32 v146, v146, s53
    s_waitcnt lgkmcnt(0)
L_r119:
    v_perm_b32 v156, v172, v168, s90
    v_perm_b32 v172, v172, v168, s91
    v_perm_b32 v157, v173, v169, s90
    v_perm_b32 v173, v173, v169, s91
    v_perm_b32 v158, v174, v170, s90
    v_perm_b32 v174, v174, v170, s91
    v_perm_b32 v159, v175, v171, s90
    v_perm_b32 v175, v175, v171, s91
    v_dot2c_f32_bf16 v32, v156, v24
    v_dot2c_f32_bf16 v33, v172, v24
    v_dot2c_f32_bf16 v34, v157, v24
    v_dot2c_f32_bf16 v35, v173, v24
    v_dot2c_f32_bf16 v36, v158, v24
    v_dot2c_f32_bf16 v37, v174, v24
    v_dot2c_f32_bf16 v38, v159, v24
    v_dot2c_f32_bf16 v39, v175, v24
    v_perm_b32 v156, v180, v176, s90
    v_perm_b32 v180, v180, v176, s91
    v_perm_b32 v157, v181, v177, s90
    v_perm_b32 v181, v181, v177, s91
    v_perm_b32 v158, v182, v178, s90
    v_perm_b32 v182, v182, v178, s91
    v_perm_b32 v159, v183, v179, s90
    v_perm_b32 v183, v183, v179, s91
    v_dot2c_f32_bf16 v32, v156, v25
    v_dot2c_f32_bf16 v33, v180, v25
    v_dot2c_f32_bf16 v34, v157, v25
    v_dot2c_f32_bf16 v35, v181, v25
    v_dot2c_f32_bf16 v36, v158, v25
    v_dot2c_f32_bf16 v37, v182, v25
    v_dot2c_f32_bf16 v38, v159, v25
    v_dot2c_f32_bf16 v39, v183, v25
    v_perm_b32 v156, v188, v184, s90
    v_perm_b32 v188, v188, v184, s91
    v_perm_b32 v157, v189, v185, s90
    v_perm_b32 v189, v189, v185, s91
    v_perm_b32 v158, v190, v186, s90
    v_perm_b32 v190, v190, v186, s91
    v_perm_b32 v159, v191, v187, s90
    v_perm_b32 v191, v191, v187, s91
    v_dot2c_f32_bf16 v32, v156, v26
    v_dot2c_f32_bf16 v33, v188, v26
    v_dot2c_f32_bf16 v34, v157, v26
    v_dot2c_f32_bf16 v35, v189, v26
    v_dot2c_f32_bf16 v36, v158, v26
    v_dot2c_f32_bf16 v37, v190, v26
    v_dot2c_f32_bf16 v38, v159, v26
    v_dot2c_f32_bf16 v39, v191, v26
    v_perm_b32 v156, v196, v192, s90
    v_perm_b32 v196, v196, v192, s91
    v_perm_b32 v157, v197, v193, s90
    v_perm_b32 v197, v197, v193, s91
    v_perm_b32 v158, v198, v194, s90
    v_perm_b32 v198, v198, v194, s91
    v_perm_b32 v159, v199, v195, s90
    v_perm_b32 v199, v199, v195, s91
    v_dot2c_f32_bf16 v32, v156, v27
    v_dot2c_f32_bf16 v33, v196, v27
    v_dot2c_f32_bf16 v34, v157, v27
    v_dot2c_f32_bf16 v35, v197, v27
    v_dot2c_f32_bf16 v36, v158, v27
    v_dot2c_f32_bf16 v37, v198, v27
    v_dot2c_f32_bf16 v38, v159, v27
    v_dot2c_f32_bf16 v39, v199, v27
    v_perm_b32 v156, v204, v200, s90
    v_perm_b32 v204, v204, v200, s91
    v_perm_b32 v157, v205, v201, s90
    v_perm_b32 v205, v205, v201, s91
    v_perm_b32 v158, v206, v202, s90
    v_perm_b32 v206, v206, v202, s91
    v_perm_b32 v159, v207, v203, s90
    v_perm_b32 v207, v207, v203, s91
    v_dot2c_f32_bf16 v32, v156, v28
    v_dot2c_f32_bf16 v33, v204, v28
    v_dot2c_f32_bf16 v34, v157, v28
    v_dot2c_f32_bf16 v35, v205, v28
    v_dot2c_f32_bf16 v36, v158, v28
    v_dot2c_f32_bf16 v37, v206, v28
    v_dot2c_f32_bf16 v38, v159, v28
    v_dot2c_f32_bf16 v39, v207, v28
    v_perm_b32 v156, v212, v208, s90
    v_perm_b32 v212, v212, v208, s91
    v_perm_b32 v157, v213, v209, s90
    v_perm_b32 v213, v213, v209, s91
    v_perm_b32 v158, v214, v210, s90
    v_perm_b32 v214, v214, v210, s91
    v_perm_b32 v159, v215, v211, s90
    v_perm_b32 v215, v215, v211, s91
    v_dot2c_f32_bf16 v32, v156, v29
    v_dot2c_f32_bf16 v33, v212, v29
    v_dot2c_f32_bf16 v34, v157, v29
    v_dot2c_f32_bf16 v35, v213, v29
    v_dot2c_f32_bf16 v36, v158, v29
    v_dot2c_f32_bf16 v37, v214, v29
    v_dot2c_f32_bf16 v38, v159, v29
    v_dot2c_f32_bf16 v39, v215, v29
    v_perm_b32 v156, v220, v216, s90
    v_perm_b32 v220, v220, v216, s91
    v_perm_b32 v157, v221, v217, s90
    v_perm_b32 v221, v221, v217, s91
    v_perm_b32 v158, v222, v218, s90
    v_perm_b32 v222, v222, v218, s91
    v_perm_b32 v159, v223, v219, s90
    v_perm_b32 v223, v223, v219, s91
    v_dot2c_f32_bf16 v32, v156, v30
    v_dot2c_f32_bf16 v33, v220, v30
    v_dot2c_f32_bf16 v34, v157, v30
    v_dot2c_f32_bf16 v35, v221, v30
    v_dot2c_f32_bf16 v36, v158, v30
    v_dot2c_f32_bf16 v37, v222, v30
    v_dot2c_f32_bf16 v38, v159, v30
    v_dot2c_f32_bf16 v39, v223, v30
    v_permlane32_swap_b32 v32, v36
    v_permlane32_swap_b32 v33, v37
    v_permlane32_swap_b32 v34, v38
    v_permlane32_swap_b32 v35, v39
    v_add_f32 v32, v32, v36
    v_add_f32 v33, v33, v37
    v_add_f32 v34, v34, v38
    v_add_f32 v35, v35, v39
    s_nop 0
    v_permlane16_swap_b32 v32, v34
    v_permlane16_swap_b32 v33, v35
    v_add_f32 v32, v32, v34
    v_add_f32 v33, v33, v35
    s_nop 0
    v_add_f32_dpp v32, v32, v32 row_ror:8 row_mask:0xf bank_mask:0xf
    v_add_f32_dpp v33, v33, v33 row_ror:8 row_mask:0xf bank_mask:0xf
    v_bfi_b32 v32, v144, v145, v32
    v_bfi_b32 v33, v144, v146, v33
    s_mov_b32 exec_lo, 0x00ff00ff
    s_mov_b32 exec_hi, 0x00ff00ff
    buffer_store_dwordx2 v[32:33], v151, s[56:59], s45 offen sc1
    s_mov_b64 exec, -1
    v_mov_b32 v144, 0xff
    s_cmp_ge_u32 s2, 112
    s_cbranch_scc1 L_noz18
    buffer_load_ushort v9, v160, s[28:31], s89 offen
    v_mul_u32_u24 v161, 1792, v4
    v_lshl_add_u32 v161, v3, 2, v161
    s_lshl_b32 s62, s2, 4
    s_add_u32 s62, s62, 163840
    v_lshlrev_b32 v155, 3, v3
    v_lshrrev_b32 v155, v155, s52
    s_sleep 64
L_pz22:
    buffer_load_dword v112, v161, s[56:59], s62 offen sc1
    s_waitcnt vmcnt(0)
    v_xor_b32 v156, v155, v112
    v_and_b32 v156, v144, v156
    v_cmp_ne_u32 vcc, 0, v156
    s_cbranch_vccz L_pzo23
    s_sleep 64
    s_sub_u32 s99, s99, 1
    s_cbranch_scc0 L_pz22
    s_branch L_end
L_pzo23:
    s_movk_i32 s62, 0x80
    v_bfi_b32 v112, v144, s62, v112
    s_nop 1
    v_add_f32_dpp v112, v112, v112 quad_perm:[1,0,3,2] row_mask:0xf bank_mask:0xf
    s_nop 1
    v_add_f32_dpp v112, v112, v112 quad_perm:[2,3,0,1] row_mask:0xf bank_mask:0xf
    s_nop 1
    v_add_f32_dpp v112, v112, v112 row_half_mirror row_mask:0xf bank_mask:0xf
    s_nop 1
    v_add_f32_dpp v112, v112, v112 row_mirror row_mask:0xf bank_mask:0xf
    v_cvt_pk_bf16_f32 v112, v112, v112
    v_and_b32 v112, 0xffff0000, v112
    s_mov_b32 s62, 3216550459
    v_mul_f32 v156, s62, v112
    v_exp_f32 v156, v156
    s_nop 0
    v_add_f32 v156, 1.0, v156
    v_rcp_f32 v156, v156
    s_nop 0
    v_mul_f32 v112, v112, v156
    v_cvt_pk_bf16_f32 v112, v112, v112
    v_and_b32 v112, 0xffff0000, v112
    v_mov_b32 v8, v112
    v_lshlrev_b32 v9, 16, v9
L_noz18:
    v_mov_b32 v144, 15
    s_mov_b32 s62, s87
    s_lshl_b32 s63, s26, 10
    s_add_u32 s63, s63, 65536
    v_lshrrev_b32 v161, 2, v0
    v_lshlrev_b32 v161, 4, v161
    s_mov_b32 s61, 1035512379
L_tw24:
    ds_read_b32 v156, v165 offset:8
    s_waitcnt lgkmcnt(0)
    v_cmp_eq_u32 vcc, 0, v156
    s_cbranch_vccz L_two25
    s_sleep 8
    s_sub_u32 s99, s99, 1
    s_cbranch_scc0 L_tw24
    s_branch L_end
L_two25:
    s_mul_i32 s60, s2, 14336
    s_mov_b32 exec_hi, 0x00ffffff
    buffer_load_dwordx4 v[48:51], v154, s[36:39], s60 offen offset:0 nt
    buffer_load_dwordx4 v[52:55], v154, s[36:39], s60 offen offset:896 nt
    buffer_load_dwordx4 v[56:59], v154, s[36:39], s60 offen offset:1792 nt
    buffer_load_dwordx4 v[60:63], v154, s[36:39], s60 offen offset:2688 nt
    s_add_u32 s60, s60, 3584
    buffer_load_dwordx4 v[64:67], v154, s[36:39], s60 offen offset:0 nt
    buffer_load_dwordx4 v[68:71], v154, s[36:39], s60 offen offset:896 nt
    buffer_load_dwordx4 v[72:75], v154, s[36:39], s60 offen offset:1792 nt
    buffer_load_dwordx4 v[76:79], v154, s[36:39], s60 offen offset:2688 nt
    s_add_u32 s60, s60, 3584
    buffer_load_dwordx4 v[80:83], v154, s[36:39], s60 offen offset:0 nt
    buffer_load_dwordx4 v[84:87], v154, s[36:39], s60 offen offset:896 nt
    buffer_load_dwordx4 v[88:91], v154, s[36:39], s60 offen offset:1792 nt
    buffer_load_dwordx4 v[92:95], v154, s[36:39], s60 offen offset:2688 nt
    s_add_u32 s60, s60, 3584
    buffer_load_dwordx4 v[96:99], v154, s[36:39], s60 offen offset:0 nt
    buffer_load_dwordx4 v[100:103], v154, s[36:39], s60 offen offset:896 nt
    buffer_load_dwordx4 v[104:107], v154, s[36:39], s60 offen offset:1792 nt
    buffer_load_dwordx4 v[108:111], v154, s[36:39], s60 offen offset:2688 nt
    s_mov_b32 exec_hi, -1
    s_waitcnt vmcnt(0)
    v_perm_b32 v162, v52, v48, s90
    v_perm_b32 v52, v52, v48, s91
    v_mov_b32 v48, v162
    v_perm_b32 v162, v53, v49, s90
    v_perm_b32 v53, v53, v49, s91
    v_mov_b32 v49, v162
    v_perm_b32 v162, v54, v50, s90
    v_perm_b32 v54, v54, v50, s91
    v_mov_b32 v50, v162
    v_perm_b32 v162, v55, v51, s90
    v_perm_b32 v55, v55, v51, s91
    v_mov_b32 v51, v162
    v_perm_b32 v162, v60, v56, s90
    v_perm_b32 v60, v60, v56, s91
    v_mov_b32 v56, v162
    v_perm_b32 v162, v61, v57, s90
    v_perm_b32 v61, v61, v57, s91
    v_mov_b32 v57, v162
    v_perm_b32 v162, v62, v58, s90
    v_perm_b32 v62, v62, v58, s91
    v_mov_b32 v58, v162
    v_perm_b32 v162, v63, v59, s90
    v_perm_b32 v63, v63, v59, s91
    v_mov_b32 v59, v162
    v_perm_b32 v162, v68, v64, s90
    v_perm_b32 v68, v68, v64, s91
    v_mov_b32 v64, v162
    v_perm_b32 v162, v69, v65, s90
    v_perm_b32 v69, v69, v65, s91
    v_mov_b32 v65, v162
    v_perm_b32 v162, v70, v66, s90
    v_perm_b32 v70, v70, v66, s91
    v_mov_b32 v66, v162
    v_perm_b32 v162, v71, v67, s90
    v_perm_b32 v71, v71, v67, s91
    v_mov_b32 v67, v162
    v_perm_b32 v162, v76, v72, s90
    v_perm_b32 v76, v76, v72, s91
    v_mov_b32 v72, v162
    v_perm_b32 v162, v77, v73, s90
    v_perm_b32 v77, v77, v73, s91
    v_mov_b32 v73, v162
    v_perm_b32 v162, v78, v74, s90
    v_perm_b32 v78, v78, v74, s91
    v_mov_b32 v74, v162
    v_perm_b32 v162, v79, v75, s90
    v_perm_b32 v79, v79, v75, s91
    v_mov_b32 v75, v162
    v_perm_b32 v162, v84, v80, s90
    v_perm_b32 v84, v84, v80, s91
    v_mov_b32 v80, v162
    v_perm_b32 v162, v85, v81, s90
    v_perm_b32 v85, v85, v81, s91
    v_mov_b32 v81, v162
    v_perm_b32 v162, v86, v82, s90
    v_perm_b32 v86, v86, v82, s91
    v_mov_b32 v82, v162
    v_perm_b32 v162, v87, v83, s90
    v_perm_b32 v87, v87, v83, s91
    v_mov_b32 v83, v162
    v_perm_b32 v162, v92, v88, s90
    v_perm_b32 v92, v92, v88, s91
    v_mov_b32 v88, v162
    v_perm_b32 v162, v93, v89, s90
    v_perm_b32 v93, v93, v89, s91
    v_mov_b32 v89, v162
    v_perm_b32 v162, v94, v90, s90
    v_perm_b32 v94, v94, v90, s91
    v_mov_b32 v90, v162
    v_perm_b32 v162, v95, v91, s90
    v_perm_b32 v95, v95, v91, s91
    v_mov_b32 v91, v162
    v_perm_b32 v162, v100, v96, s90
    v_perm_b32 v100, v100, v96, s91
    v_mov_b32 v96, v162
    v_perm_b32 v162, v101, v97, s90
    v_perm_b32 v101, v101, v97, s91
    v_mov_b32 v97, v162
    v_perm_b32 v162, v102, v98, s90
    v_perm_b32 v102, v102, v98, s91
    v_mov_b32 v98, v162
    v_perm_b32 v162, v103, v99, s90
    v_perm_b32 v103, v103, v99, s91
    v_mov_b32 v99, v162
    v_perm_b32 v162, v108, v104, s90
    v_perm_b32 v108, v108, v104, s91
    v_mov_b32 v104, v162
    v_perm_b32 v162, v109, v105, s90
    v_perm_b32 v109, v109, v105, s91
    v_mov_b32 v105, v162
    v_perm_b32 v162, v110, v106, s90
    v_perm_b32 v110, v110, v106, s91
    v_mov_b32 v106, v162
    v_perm_b32 v162, v111, v107, s90
    v_perm_b32 v111, v111, v107, s91
    v_mov_b32 v107, v162
    s_setprio 3
    s_barrier
    s_mov_b64 s[4:5], -1
    s_mov_b64 s[6:7], -1
    s_mov_b64 s[8:9], -1
    s_mov_b64 s[10:11], -1
L_po26:
    s_mov_b64 exec, s[4:5]
    buffer_load_dwordx4 v[128:131], v161, s[56:59], s63 offen offset:0 sc1
    buffer_load_dwordx4 v[112:115], v154, s[56:59], s62 offen offset:0 sc1
    s_mov_b64 exec, s[6:7]
    buffer_load_dwordx4 v[132:135], v161, s[56:59], s63 offen offset:256 sc1
    buffer_load_dwordx4 v[116:119], v154, s[56:59], s62 offen offset:1024 sc1
    s_mov_b64 exec, s[8:9]
    buffer_load_dwordx4 v[136:139], v161, s[56:59], s63 offen offset:512 sc1
    buffer_load_dwordx4 v[120:123], v154, s[56:59], s62 offen offset:2048 sc1
    s_mov_b64 exec, s[10:11]
    buffer_load_dwordx4 v[140:143], v161, s[56:59], s63 offen offset:768 sc1
    buffer_load_dwordx4 v[124:127], v154, s[56:59], s62 offen offset:3072 sc1
    s_mov_b64 exec, -1
    s_waitcnt vmcnt(0)
    v_xor_b32 v156, s52, v112
    v_xor_b32 v157, s52, v116
    v_xor_b32 v158, s52, v120
    v_xor_b32 v159, s52, v124
    v_bitop3_b32 v156, v156, v113, s100 bitop3:0xf6
    v_bitop3_b32 v157, v157, v117, s100 bitop3:0xf6
    v_bitop3_b32 v158, v158, v121, s100 bitop3:0xf6
    v_bitop3_b32 v159, v159, v125, s100 bitop3:0xf6
    v_bitop3_b32 v156, v156, v114, s53 bitop3:0xf6
    v_bitop3_b32 v157, v157, v118, s53 bitop3:0xf6
    v_bitop3_b32 v158, v158, v122, s53 bitop3:0xf6
    v_bitop3_b32 v159, v159, v126, s53 bitop3:0xf6
    v_bitop3_b32 v156, v156, v115, s101 bitop3:0xf6
    v_bitop3_b32 v157, v157, v119, s101 bitop3:0xf6
    v_bitop3_b32 v158, v158, v123, s101 bitop3:0xf6
    v_bitop3_b32 v159, v159, v127, s101 bitop3:0xf6
    v_and_b32 v156, v144, v156
    v_and_b32 v157, v144, v157
    v_and_b32 v158, v144, v158
    v_and_b32 v159, v144, v159
    v_bitop3_b32 v156, v156, v130, s52 bitop3:0xf6
    v_bitop3_b32 v157, v157, v134, s52 bitop3:0xf6
    v_bitop3_b32 v158, v158, v138, s52 bitop3:0xf6
    v_bitop3_b32 v159, v159, v142, s52 bitop3:0xf6
    v_bitop3_b32 v156, v156, v131, s52 bitop3:0xf6
    v_bitop3_b32 v157, v157, v135, s52 bitop3:0xf6
    v_bitop3_b32 v158, v158, v139, s52 bitop3:0xf6
    v_bitop3_b32 v159, v159, v143, s52 bitop3:0xf6
    v_or_b32_dpp v156, v156, v156 quad_perm:[1,0,3,2] row_mask:0xf bank_mask:0xf
    v_or_b32_dpp v157, v157, v157 quad_perm:[1,0,3,2] row_mask:0xf bank_mask:0xf
    v_or_b32_dpp v158, v158, v158 quad_perm:[1,0,3,2] row_mask:0xf bank_mask:0xf
    v_or_b32_dpp v159, v159, v159 quad_perm:[1,0,3,2] row_mask:0xf bank_mask:0xf
    v_or_b32_dpp v156, v156, v156 quad_perm:[2,3,0,1] row_mask:0xf bank_mask:0xf
    v_or_b32_dpp v157, v157, v157 quad_perm:[2,3,0,1] row_mask:0xf bank_mask:0xf
    v_or_b32_dpp v158, v158, v158 quad_perm:[2,3,0,1] row_mask:0xf bank_mask:0xf
    v_or_b32_dpp v159, v159, v159 quad_perm:[2,3,0,1] row_mask:0xf bank_mask:0xf
    v_cmp_ne_u32 s[4:5], 0, v156
    v_cmp_ne_u32 s[6:7], 0, v157
    v_cmp_ne_u32 s[8:9], 0, v158
    v_cmp_ne_u32 s[10:11], 0, v159
    s_or_b64 vcc, s[4:5], s[6:7]
    s_or_b64 vcc, vcc, s[8:9]
    s_or_b64 vcc, vcc, s[10:11]
    s_cbranch_scc0 L_poo27
    s_sub_u32 s99, s99, 1
    s_cbranch_scc0 L_po26
    s_branch L_end
L_poo27:
    v_max3_f32 v156, v128, v132, v136
    v_max_f32 v156, v156, v140
    s_nop 1
    v_max_f32_dpp v156, v156, v156 row_ror:4 row_mask:0xf bank_mask:0xf
    s_nop 1
    v_max_f32_dpp v156, v156, v156 row_ror:8 row_mask:0xf bank_mask:0xf
    v_mov_b32 v157, v156
    s_nop 1
    v_permlane16_swap_b32 v156, v157
    v_max_f32 v156, v156, v157
    v_mov_b32 v157, v156
    s_nop 1
    v_permlane32_swap_b32 v156, v157
    v_max_f32 v156, v156, v157
    v_mul_f32 v156, s61, v156
    v_fma_f32 v128, v128, s61, -v156
    v_fma_f32 v132, v132, s61, -v156
    v_fma_f32 v136, v136, s61, -v156
    v_fma_f32 v140, v140, s61, -v156
    v_exp_f32 v128, v128
    v_exp_f32 v132, v132
    v_exp_f32 v136, v136
    v_exp_f32 v140, v140
    v_mul_f32 v158, v128, v129
    v_mul_f32 v12, v128, v112
    v_mul_f32 v13, v128, v113
    v_mul_f32 v14, v128, v114
    v_mul_f32 v15, v128, v115
    v_fmac_f32 v158, v132, v133
    v_fmac_f32 v12, v132, v116
    v_fmac_f32 v13, v132, v117
    v_fmac_f32 v14, v132, v118
    v_fmac_f32 v15, v132, v119
    v_fmac_f32 v158, v136, v137
    v_fmac_f32 v12, v136, v120
    v_fmac_f32 v13, v136, v121
    v_fmac_f32 v14, v136, v122
    v_fmac_f32 v15, v136, v123
    v_fmac_f32 v158, v140, v141
    v_fmac_f32 v12, v140, v124
    v_fmac_f32 v13, v140, v125
    v_fmac_f32 v14, v140, v126
    v_fmac_f32 v15, v140, v127
    s_nop 0
    v_permlane32_swap_b32 v12, v14
    v_permlane32_swap_b32 v13, v15
    v_add_f32_dpp v158, v158, v158 row_ror:4 row_mask:0xf bank_mask:0xf
    v_add_f32 v12, v12, v14
    v_add_f32 v13, v13, v15
    v_add_f32_dpp v158, v158, v158 row_ror:8 row_mask:0xf bank_mask:0xf
    s_nop 0
    v_permlane16_swap_b32 v12, v13
    v_mov_b32 v157, v158
    v_add_f32 v12, v12, v13
    s_nop 0
    v_permlane16_swap_b32 v158, v157
    v_add_f32_dpp v12, v12, v12 row_ror:4 row_mask:0xf bank_mask:0xf
    v_add_f32 v158, v158, v157
    v_mov_b32 v157, v158
    v_add_f32_dpp v12, v12, v12 row_ror:8 row_mask:0xf bank_mask:0xf
    s_nop 0
    v_permlane32_swap_b32 v158, v157
    v_add_f32 v158, v158, v157
    v_rcp_f32 v158, v158
    s_nop 0
    v_mul_f32 v12, v12, v158
    v_mov_b32 v13, v12
    s_nop 1
    v_permlane16_swap_b32 v12, v13
    v_cvt_pk_bf16_f32 v12, v12, v13
    s_nop 0
    v_readlane_b32 s4, v12, 0
    v_readlane_b32 s5, v12, 32
    v_readlane_b32 s6, v12, 1
    v_readlane_b32 s7, v12, 33
    v_readlane_b32 s8, v12, 2
    v_readlane_b32 s9, v12, 34
    v_readlane_b32 s10, v12, 3
    v_readlane_b32 s11, v12, 35
    v_dot2_f32_bf16 v32, v48, s4, 0
    v_dot2_f32_bf16 v33, v52, s4, 0
    v_dot2_f32_bf16 v34, v49, s4, 0
    v_dot2_f32_bf16 v35, v53, s4, 0
    v_dot2_f32_bf16 v36, v50, s4, 0
    v_dot2_f32_bf16 v37, v54, s4, 0
    v_dot2_f32_bf16 v38, v51, s4, 0
    v_dot2_f32_bf16 v39, v55, s4, 0
    v_dot2_f32_bf16 v32, v56, s5, v32
    v_dot2_f32_bf16 v33, v60, s5, v33
    v_dot2_f32_bf16 v34, v57, s5, v34
    v_dot2_f32_bf16 v35, v61, s5, v35
    v_dot2_f32_bf16 v36, v58, s5, v36
    v_dot2_f32_bf16 v37, v62, s5, v37
    v_dot2_f32_bf16 v38, v59, s5, v38
    v_dot2_f32_bf16 v39, v63, s5, v39
    v_dot2_f32_bf16 v32, v64, s6, v32
    v_dot2_f32_bf16 v33, v68, s6, v33
    v_dot2_f32_bf16 v34, v65, s6, v34
    v_dot2_f32_bf16 v35, v69, s6, v35
    v_dot2_f32_bf16 v36, v66, s6, v36
    v_dot2_f32_bf16 v37, v70, s6, v37
    v_dot2_f32_bf16 v38, v67, s6, v38
    v_dot2_f32_bf16 v39, v71, s6, v39
    v_dot2_f32_bf16 v32, v72, s7, v32
    v_dot2_f32_bf16 v33, v76, s7, v33
    v_dot2_f32_bf16 v34, v73, s7, v34
    v_dot2_f32_bf16 v35, v77, s7, v35
    v_dot2_f32_bf16 v36, v74, s7, v36
    v_dot2_f32_bf16 v37, v78, s7, v37
    v_dot2_f32_bf16 v38, v75, s7, v38
    v_dot2_f32_bf16 v39, v79, s7, v39
    v_dot2_f32_bf16 v32, v80, s8, v32
    v_dot2_f32_bf16 v33, v84, s8, v33
    v_dot2_f32_bf16 v34, v81, s8, v34
    v_dot2_f32_bf16 v35, v85, s8, v35
    v_dot2_f32_bf16 v36, v82, s8, v36
    v_dot2_f32_bf16 v37, v86, s8, v37
    v_dot2_f32_bf16 v38, v83, s8, v38
    v_dot2_f32_bf16 v39, v87, s8, v39
    v_dot2_f32_bf16 v32, v88, s9, v32
    v_dot2_f32_bf16 v33, v92, s9, v33
    v_dot2_f32_bf16 v34, v89, s9, v34
    v_dot2_f32_bf16 v35, v93, s9, v35
    v_dot2_f32_bf16 v36, v90, s9, v36
    v_dot2_f32_bf16 v37, v94, s9, v37
    v_dot2_f32_bf16 v38, v91, s9, v38
    v_dot2_f32_bf16 v39, v95, s9, v39
    v_dot2_f32_bf16 v32, v96, s10, v32
    v_dot2_f32_bf16 v33, v100, s10, v33
    v_dot2_f32_bf16 v34, v97, s10, v34
    v_dot2_f32_bf16 v35, v101, s10, v35
    v_dot2_f32_bf16 v36, v98, s10, v36
    v_dot2_f32_bf16 v37, v102, s10, v37
    v_dot2_f32_bf16 v38, v99, s10, v38
    v_dot2_f32_bf16 v39, v103, s10, v39
    v_dot2_f32_bf16 v32, v104, s11, v32
    v_dot2_f32_bf16 v33, v108, s11, v33
    v_dot2_f32_bf16 v34, v105, s11, v34
    v_dot2_f32_bf16 v35, v109, s11, v35
    v_dot2_f32_bf16 v36, v106, s11, v36
    v_dot2_f32_bf16 v37, v110, s11, v37
    v_dot2_f32_bf16 v38, v107, s11, v38
    v_dot2_f32_bf16 v39, v111, s11, v39
    v_bfi_b32 v32, v147, s52, v32
    v_bfi_b32 v33, v147, s53, v33
    v_bfi_b32 v34, v147, s54, v34
    v_bfi_b32 v35, v147, s55, v35
    v_bfi_b32 v36, v147, s52, v36
    v_bfi_b32 v37, v147, s53, v37
    v_bfi_b32 v38, v147, s54, v38
    v_bfi_b32 v39, v147, s55, v39
    s_mov_b32 exec_hi, 0x00ffffff
    buffer_store_dwordx4 v[32:35], v149, s[56:59], s96 offen sc1
    buffer_store_dwordx4 v[36:39], v149, s[56:59], s97 offen sc1
    s_mov_b64 exec, -1
    s_cmp_ge_u32 s2, 112
    s_cbranch_scc1 L_hend
    s_mov_b64 s[4:5], -1
    s_mov_b64 s[6:7], -1
    s_mov_b64 s[8:9], -1
    s_mov_b64 s[10:11], -1
L_py28:
    s_mov_b64 exec, s[4:5]
    buffer_load_dwordx4 v[48:51], v154, s[56:59], s86 offen offset:0 sc1
    s_mov_b64 exec, s[6:7]
    buffer_load_dwordx4 v[52:55], v154, s[56:59], s86 offen offset:1024 sc1
    s_mov_b64 exec, s[8:9]
    buffer_load_dwordx4 v[56:59], v154, s[56:59], s86 offen offset:2048 sc1
    s_mov_b64 exec, s[10:11]
    buffer_load_dwordx4 v[60:63], v154, s[56:59], s86 offen offset:3072 sc1
    s_mov_b64 exec, -1
    s_waitcnt vmcnt(0)
    v_xor_b32 v156, s52, v48
    v_xor_b32 v157, s52, v52
    v_xor_b32 v158, s52, v56
    v_xor_b32 v159, s52, v60
    v_bitop3_b32 v156, v156, v49, s53 bitop3:0xf6
    v_bitop3_b32 v157, v157, v53, s53 bitop3:0xf6
    v_bitop3_b32 v158, v158, v57, s53 bitop3:0xf6
    v_bitop3_b32 v159, v159, v61, s53 bitop3:0xf6
    v_bitop3_b32 v156, v156, v50, s54 bitop3:0xf6
    v_bitop3_b32 v157, v157, v54, s54 bitop3:0xf6
    v_bitop3_b32 v158, v158, v58, s54 bitop3:0xf6
    v_bitop3_b32 v159, v159, v62, s54 bitop3:0xf6
    v_bitop3_b32 v156, v156, v51, s55 bitop3:0xf6
    v_bitop3_b32 v157, v157, v55, s55 bitop3:0xf6
    v_bitop3_b32 v158, v158, v59, s55 bitop3:0xf6
    v_bitop3_b32 v159, v159, v63, s55 bitop3:0xf6
    v_and_b32 v156, v147, v156
    v_and_b32 v157, v147, v157
    v_and_b32 v158, v147, v158
    v_and_b32 v159, v147, v159
    v_cmp_ne_u32 s[4:5], 0, v156
    v_cmp_ne_u32 s[6:7], 0, v157
    v_cmp_ne_u32 s[8:9], 0, v158
    v_cmp_ne_u32 s[10:11], 0, v159
    s_or_b64 vcc, s[4:5], s[6:7]
    s_or_b64 vcc, vcc, s[8:9]
    s_or_b64 vcc, vcc, s[10:11]
    s_cbranch_scc0 L_pyo29
    s_sub_u32 s99, s99, 1
    s_cbranch_scc0 L_py28
    s_branch L_end
L_pyo29:
    s_movk_i32 s62, 0x200
    v_bfi_b32 v48, v147, s62, v48
    v_bfi_b32 v49, v147, s62, v49
    v_bfi_b32 v50, v147, s62, v50
    v_bfi_b32 v51, v147, s62, v51
    v_bfi_b32 v52, v147, s62, v52
    v_bfi_b32 v53, v147, s62, v53
    v_bfi_b32 v54, v147, s62, v54
    v_bfi_b32 v55, v147, s62, v55
    v_bfi_b32 v56, v147, s62, v56
    v_bfi_b32 v57, v147, s62, v57
    v_bfi_b32 v58, v147, s62, v58
    v_bfi_b32 v59, v147, s62, v59
    v_bfi_b32 v60, v147, s62, v60
    v_bfi_b32 v61, v147, s62, v61
    v_bfi_b32 v62, v147, s62, v62
    v_bfi_b32 v63, v147, s62, v63
    v_add_f32 v36, v48, v52
    v_add_f32 v44, v56, v60
    v_add_f32 v37, v49, v53
    v_add_f32 v45, v57, v61
    v_add_f32 v38, v50, v54
    v_add_f32 v46, v58, v62
    v_add_f32 v39, v51, v55
    v_add_f32 v47, v59, v63
    v_add_f32 v36, v36, v44
    v_add_f32 v37, v37, v45
    v_add_f32 v38, v38, v46
    v_add_f32 v39, v39, v47
    s_nop 0
    v_permlane32_swap_b32 v36, v38
    v_permlane32_swap_b32 v37, v39
    v_add_f32 v36, v36, v38
    v_add_f32 v37, v37, v39
    s_nop 1
    v_permlane16_swap_b32 v36, v37
    v_add_f32 v36, v36, v37
    s_nop 1
    v_add_f32_dpp v36, v36, v36 quad_perm:[1,0,3,2] row_mask:0xf bank_mask:0xf
    s_nop 1
    v_add_f32_dpp v36, v36, v36 quad_perm:[2,3,0,1] row_mask:0xf bank_mask:0xf
    s_nop 1
    v_add_f32_dpp v36, v36, v36 row_half_mirror row_mask:0xf bank_mask:0xf
    s_nop 1
    v_add_f32_dpp v36, v36, v36 row_mirror row_mask:0xf bank_mask:0xf
    v_cvt_pk_bf16_f32 v36, v36, v36
    v_and_b32 v36, 0xffff0000, v36
    v_mul_f32 v36, v36, v8
    v_cvt_pk_bf16_f32 v36, v36, v36
    v_and_b32 v36, 0xffff0000, v36
    v_add_f32 v36, v36, v9
    v_cvt_pk_bf16_f32 v36, v36, v36
    s_mov_b32 exec_lo, 0x00010001
    s_mov_b32 exec_hi, 0x00010001
    buffer_store_short v36, v160, s[48:51], s89 offen sc1
    s_cmp_eq_u32 s2, 0
    s_mov_b32 s62, 229376
    s_cselect_b32 s62, s62, 0x80000000
    v_mov_b32 v156, s52
    s_mov_b64 exec, 1
    buffer_store_dword v156, off, s[56:59], s62 sc1
L_hend:
L_end:
    s_endpgm
.section .rodata,"a"
.p2align 6
.amdhsa_kernel recurrent_scan__mha_block_cached__dense_activation_silu__decode_kernel
  .amdhsa_next_free_vgpr 232
  .amdhsa_next_free_sgpr 102
  .amdhsa_accum_offset 232
  .amdhsa_group_segment_fixed_size 0
  .amdhsa_kernarg_size 88
  .amdhsa_user_sgpr_count 2
  .amdhsa_user_sgpr_kernarg_segment_ptr 1
  .amdhsa_system_sgpr_workgroup_id_x 1
  .amdhsa_float_denorm_mode_32 3
.end_amdhsa_kernel
```
